```python
import torch

def _softmax(x, axis=-1):
    return torch.softmax(x, dim=axis)
def _gelu(x):
    return torch.nn.functional.gelu(x, approximate="tanh")
def _silu(x):
    return torch.nn.functional.silu(x)
def _sigmoid(x):
    return torch.sigmoid(x)
def _layernorm(x, axis=-1, eps=1e-5):
    m = x.mean(dim=axis, keepdim=True)
    v = x.var(dim=axis, keepdim=True, unbiased=False)
    return (x - m) / torch.sqrt(v + eps)
def _scatter_add(tgt, idx, src, axis=0):
    return tgt.clone().index_add_(axis, idx, src)
def _segment_sum(src, seg, n):
    out = torch.zeros((n,) + src.shape[1:], dtype=src.dtype)
    return out.index_add_(0, seg, src)
def _pad(x, pw):
    flat = tuple(v for pair in reversed(pw) for v in pair)
    return torch.nn.functional.pad(x, flat)

kernel_name = 'recurrent_scan__mha_block__glu_gated_glu__prompt'

def setup_inputs():

    _w = (lambda a: (lambda t: t.to(torch.bfloat16) if t.is_floating_point() else t)(torch.as_tensor(a)))
    def _A_setup():
        B, S, D, H = 1, 2048, 448, 16
        return {
            "x": _w((lambda *s: torch.randn(*s, dtype=torch.bfloat16) * 0.05)(B, S, D)),
            "wqkv": _w((lambda *s: torch.randn(*s, dtype=torch.bfloat16) * 0.05)(D, 3 * D)),
            "wo": _w((lambda *s: torch.randn(*s, dtype=torch.bfloat16) * 0.05)(D, D)),
        }
    _A_in = _A_setup()

    def _B_setup():
        B, S, D, F = 1, 2048, 448, 1792
        return {
            "x": _w((lambda *s: torch.randn(*s, dtype=torch.bfloat16) * 0.05)(B, S, D)),
            "w_gate": _w((lambda *s: torch.randn(*s, dtype=torch.bfloat16) * 0.05)(D, F)),
            "w_up": _w((lambda *s: torch.randn(*s, dtype=torch.bfloat16) * 0.05)(D, F)),
            "w_down": _w((lambda *s: torch.randn(*s, dtype=torch.bfloat16) * 0.05)(F, D)),
        }
    _B_in = _B_setup()

    return {
        "A_x": _A_in["x"],
        "A_wqkv": _A_in["wqkv"],
        "A_wo": _A_in["wo"],
        "B_x": _B_in["x"],
        "B_w_gate": _B_in["w_gate"],
        "B_w_up": _B_in["w_up"],
        "B_w_down": _B_in["w_down"],
    }

def reference(A_x, A_wqkv, A_wo, B_x, B_w_gate, B_w_up, B_w_down):
    def _A_ref(x, wqkv, wo):
        B, S, D = x.shape
        H = 16
        Dh = D // H
        qkv = (lambda x, *d: x.permute(*d))((x @ wqkv).reshape(B, S, 3, H, Dh), 2, 0, 3, 1, 4)
        q, k, v = qkv[0], qkv[1], qkv[2]
        scores = torch.einsum("bhqd,bhkd->bhqk", q, k) * (Dh ** -0.5)
        p = _softmax(scores, axis=-1)
        o = torch.einsum("bhqk,bhkd->bhqd", p, v)
        return (lambda x, *d: x.permute(*d))(o, 0, 2, 1, 3).reshape(B, S, D) @ wo

    def _B_ref(x, w_gate, w_up, w_down):
        g = torch.einsum("bsd,df->bsf", x, w_gate)
        u = torch.einsum("bsd,df->bsf", x, w_up)
        h = _sigmoid(g) * u
        return torch.einsum("bsf,fd->bsd", h, w_down)

    x = A_x
    xn = _layernorm(x, axis=-1)
    s = _A_ref(xn, A_wqkv, A_wo)
    g = _silu(_B_ref(xn, B_w_gate, B_w_up, B_w_down))
    return x + s * g
```

```asm
; @launch kernel=proj_kernel grid=(256,1,1) block=(512,1,1) lds=163840
; @launch kernel=attn_kernel grid=(128,2,1) block=(512,1,1) lds=162048
.amdgcn_target "amdgcn-amd-amdhsa--gfx950"
.text
.globl proj_kernel
.p2align 8
.type proj_kernel,@function
proj_kernel:
  s_cmp_ge_u32 s2, 256
  s_cbranch_scc1 L_k1_exit
  s_load_dwordx2 s[36:37], s[0:1], 0
  s_load_dwordx2 s[40:41], s[0:1], 32
  s_load_dwordx2 s[44:45], s[0:1], 40
  v_lshrrev_b32 v1, 6, v0
  v_and_b32 v0, 63, v0
  s_and_b32 s9, s2, 7
  v_readfirstlane_b32 s3, v1
  s_lshr_b32 s10, s2, 3
  s_and_b32 s11, s9, 1
  s_lshl_b32 s11, s11, 3
  s_and_b32 s12, s10, 7
  s_add_u32 s7, s11, s12
  s_lshr_b32 s15, s9, 1
  s_lshr_b32 s8, s10, 3
  s_lshl_b32 s68, s3, 10
  s_lshl_b32 s25, s3, 11
  s_getpc_b64 s[80:81]
L_k1_pc_1:
  s_and_b32 s13, s2, -8
  s_add_u32 s13, s13, s3
  s_and_b32 s13, s13, 31
  s_lshl_b32 s13, s13, 10
  s_min_u32 s13, s13, L_text_end-proj_kernel-1024
  s_add_u32 s80, s80, proj_kernel-L_k1_pc_1
  s_addc_u32 s81, s81, -1
  v_lshl_add_u32 v128, v0, 4, s13
  global_load_dwordx4 v[128:131], v128, s[80:81]
  s_lshl_b32 s10, s8, 1
  s_add_u32 s9, s12, s10
  s_cmp_ge_u32 s9, 7
  s_cselect_b32 s10, 7, 0
  s_sub_u32 s16, s9, s10
  v_lshrrev_b32 v8, 3, v0
  v_mul_u32_u24 v8, 896, v8
  v_and_b32 v9, 7, v0
  v_lshrrev_b32 v10, 4, v0
  v_xor_b32 v9, v9, v10
  v_lshl_add_u32 v2, v9, 4, v8
  v_xor_b32 v9, 4, v9
  v_lshl_add_u32 v3, v9, 4, v8
  v_add_u32 v3, 7168, v3
  s_lshl_b32 s11, s7, 7
  s_lshl_b32 s12, s3, 4
  s_add_u32 s11, s11, s12
  s_mul_i32 s69, s11, 896
  v_bfe_u32 v8, v0, 2, 3
  v_and_b32 v9, 3, v0
  v_lshlrev_b32 v9, 4, v9
  v_lshrrev_b32 v10, 5, v0
  v_mul_u32_u24 v11, 3584, v8
  v_lshl_add_u32 v12, v10, 6, v9
  v_add_u32 v4, v11, v12
  s_mul_i32 s10, s3, 28672
  s_mul_i32 s13, s15, 896
  s_lshl_b32 s14, s8, 8
  s_add_u32 s13, s13, s14
  s_add_u32 s70, s10, s13
  s_mov_b32 s38, 1835008
  s_mov_b32 s39, 0x00020000
  s_mov_b32 s46, 1605632
  s_mov_b32 s47, 0x00020000
  s_mov_b32 s42, 1605632
  s_mov_b32 s43, 0x00020000
  s_waitcnt lgkmcnt(0)
  s_add_u32 m0, s25, 0
  s_mul_i32 s23, s16, 128
  s_add_u32 s23, s23, s69
  buffer_load_dwordx4 v2, s[36:39], s23 offen lds
  s_add_u32 m0, s25, 1024
  s_nop 0
  buffer_load_dwordx4 v3, s[36:39], s23 offen lds
  s_add_u32 m0, s68, 16384
  s_mul_i32 s24, s16, 229376
  s_add_u32 s24, s24, s70
  buffer_load_dwordx4 v4, s[40:43], s24 offen lds
  s_add_u32 m0, s68, 24576
  s_nop 0
  buffer_load_dwordx4 v4, s[44:47], s24 offen lds
  s_cmp_eq_u32 s8, 3
  s_cselect_b32 s9, 8, 32
  s_cselect_b32 s10, 8, 40
  s_load_dwordx2 s[48:49], s[0:1], s9
  s_load_dwordx2 s[52:53], s[0:1], s10
  s_load_dwordx2 s[56:57], s[0:1], 8
  s_load_dwordx2 s[64:65], s[0:1], 72
  s_add_u32 s17, s16, 1
  s_cmp_eq_u32 s17, 7
  s_cselect_b32 s17, 0, s17
  s_add_u32 s18, s17, 1
  s_cmp_eq_u32 s18, 7
  s_cselect_b32 s18, 0, s18
  s_add_u32 s19, s18, 1
  s_cmp_eq_u32 s19, 7
  s_cselect_b32 s19, 0, s19
  s_add_u32 s20, s19, 1
  s_cmp_eq_u32 s20, 7
  s_cselect_b32 s20, 0, s20
  s_add_u32 s21, s20, 1
  s_cmp_eq_u32 s21, 7
  s_cselect_b32 s21, 0, s21
  s_add_u32 s22, s21, 1
  s_cmp_eq_u32 s22, 7
  s_cselect_b32 s22, 0, s22
  s_and_b32 s4, s3, 3
  s_lshr_b32 s5, s3, 2
  s_lshl_b32 s11, s5, 1
  s_xor_b32 s6, s4, s11
  v_mul_u32_u24 v11, 2688, v8
  v_mul_u32_u24 v12, 48, v10
  v_add3_u32 v6, v11, v12, v9
  v_mov_b32 v5, v4
  s_mul_i32 s11, s3, 21504
  s_add_u32 s71, s70, 128
  s_mov_b32 s72, s71
  s_mov_b32 s74, 229376
  s_lshl_b32 s9, s15, 2
  s_and_b32 s10, s8, 1
  s_lshl_b32 s10, s10, 1
  s_add_u32 s9, s9, s10
  s_mul_i32 s12, s9, 56
  s_add_u32 s73, s11, s12
  s_cmp_lt_u32 s8, 2
  s_cselect_b32 s10, 896, 0
  s_cselect_b32 s12, 2048, 0
  s_add_u32 s73, s73, s10
  s_add_u32 s73, s73, 896
  s_add_u32 s9, s9, s5
  s_lshl_b32 s9, s9, 18
  s_add_u32 s78, s9, s12
  s_add_u32 s78, s78, 2097152
  s_lshl_b32 s14, s7, 2
  s_add_u32 s14, s14, s4
  s_lshl_b32 s9, s14, 12
  s_add_u32 s78, s78, s9
  s_mul_i32 s9, s14, 114688
  s_lshl_b32 s10, s13, 5
  s_add_u32 s9, s9, s10
  s_lshl_b32 s10, s5, 11
  s_add_u32 s9, s9, s10
  s_add_u32 s75, s9, 6291456
  s_add_u32 s76, s75, 4096
  s_mov_b32 s77, 0
  s_mov_b32 s90, 0
  s_lshl_b32 s91, s5, 3
  s_mov_b32 s50, 1605632
  s_mov_b32 s51, 0x00020000
  s_mov_b32 s54, 1605632
  s_mov_b32 s55, 0x00020000
  s_mov_b32 s58, 1204224
  s_mov_b32 s59, 0x00020000
  s_mov_b32 s66, 20971520
  s_mov_b32 s67, 0x00020000
  s_cmp_lg_u32 s8, 3
  s_cbranch_scc1 L_k1_cfg_done
  s_mul_i32 s9, s15, 224
  s_add_u32 s71, s11, s9
  s_add_u32 s72, s71, 112
  s_mov_b32 s74, 172032
  v_mov_b32 v5, v6
  s_lshl_b32 s9, s15, 2
  s_add_u32 s9, s9, s5
  s_lshl_b32 s9, s9, 17
  s_lshl_b32 s10, s14, 11
  s_add_u32 s76, s9, s10
  s_add_u32 s76, s76, 0
  s_add_u32 s77, s76, 262144
  s_mov_b32 s90, s91
  s_mov_b32 s50, s58
  s_mov_b32 s54, s58
L_k1_cfg_done:
  s_lshl_b32 s9, s2, 3
  s_add_u32 s9, s9, s3
  s_min_u32 s9, s9, 2015
  s_mov_b64 s[80:81], 0
  s_cmp_lt_u32 s9, 1568
  s_cbranch_scc0 L_k1_two
  s_load_dwordx2 s[60:61], s[0:1], 48
  s_mul_i32 s10, s9, 4682
  s_lshr_b32 s10, s10, 16
  s_mul_i32 s11, s10, 14
  s_sub_u32 s11, s9, s11
  s_mul_i32 s12, s11, 112
  s_add_u32 s12, s12, s10
  s_lshl_b32 s12, s12, 10
  s_add_u32 s79, s12, 13631488
  s_mul_i32 s10, s10, 14336
  s_mov_b32 s62, 1605632
  s_mov_b32 s63, 0x00020000
  s_branch L_k1_tdone
L_k1_two:
  s_load_dwordx2 s[60:61], s[0:1], 16
  s_sub_u32 s9, s9, 1568
  s_mul_i32 s10, s9, 4682
  s_lshr_b32 s10, s10, 16
  s_mul_i32 s11, s10, 14
  s_sub_u32 s11, s9, s11
  s_lshl_b32 s12, s11, 5
  s_add_u32 s12, s12, s10
  s_lshl_b32 s12, s12, 10
  s_add_u32 s79, s12, 15728640
  s_lshr_b32 s12, s10, 1
  s_mul_i32 s12, s12, 28
  s_and_b32 s10, s10, 1
  s_cselect_b32 s81, -1, 0
  s_lshl_b32 s10, s10, 4
  s_add_u32 s10, s10, s12
  s_mul_i32 s10, s10, 896
  s_mov_b32 s62, 401408
  s_mov_b32 s63, 0x00020000
L_k1_tdone:
  s_lshl_b32 s11, s11, 6
  s_add_u32 s26, s10, s11
  v_lshrrev_b32 v8, 2, v0
  v_mul_u32_u24 v8, 896, v8
  v_and_b32 v9, 3, v0
  v_lshl_add_u32 v7, v9, 4, v8
  v_bfe_u32 v8, v0, 2, 2
  v_lshlrev_b32 v8, 6, v8
  v_bfe_u32 v9, v0, 4, 1
  v_lshl_add_u32 v8, v9, 5, v8
  v_and_b32 v9, 3, v0
  v_lshl_add_u32 v8, v9, 3, v8
  v_lshrrev_b32 v10, 5, v0
  v_lshl_add_u32 v8, v10, 10, v8
  s_lshl_b32 s9, s5, 9
  s_lshl_b32 s10, s6, 11
  s_add_u32 s9, s9, s10
  s_add_u32 s9, s9, 0
  v_add_u32 v244, s9, v8
  v_xor_b32 v245, 2048, v244
  v_xor_b32 v246, 4096, v244
  v_xor_b32 v247, 6144, v244
  v_and_b32 v8, 31, v0
  v_bfe_u32 v9, v0, 1, 3
  v_xor_b32 v9, v9, v10
  s_lshl_b32 s9, s6, 1
  v_xor_b32 v9, s9, v9
  v_lshlrev_b32 v9, 4, v9
  v_lshl_add_u32 v9, v8, 7, v9
  s_lshl_b32 s9, s4, 12
  v_add_u32 v248, s9, v9
  v_xor_b32 v249, 32, v248
  v_xor_b32 v250, 64, v248
  v_xor_b32 v251, 96, v248
  v_lshlrev_b32 v1, 4, v0
  v_lshrrev_b32 v9, 4, v0
  v_lshrrev_b32 v11, 2, v0
  v_xor_b32 v9, v9, v11
  v_and_b32 v9, 1, v9
  v_add_u32 v9, -1, v9
  v_and_b32 v232, 0x3f803f80, v9
  v_mov_b32 v233, v232
  v_mov_b32 v234, v232
  v_mov_b32 v235, v232
  v_mov_b32 v237, 0
  v_mov_b32 v238, 0
  v_mov_b32 v239, 0
  v_mov_b32 v243, 0
  s_mov_b32 s82, 0xffff0000
  s_mov_b32 s83, 0x3e8b97f6
  s_mov_b32 s84, 0
  s_mov_b32 s85, -1
  s_mov_b32 s86, 0x10000000
  s_mov_b32 s87, 0x10000000
  s_mov_b32 s88, 0xe0000000
  s_mov_b32 s89, 0xe0000000
  v_mov_b32 v241, 0
  v_mov_b32 v242, 0
  v_lshlrev_b32 v12, 4, v8
  s_lshl_b32 s9, s5, 10
  s_lshl_b32 s10, s4, 2
  s_add_u32 s9, s9, s10
  s_add_u32 s9, s9, 155648
  v_add_u32 v255, s9, v12
  v_mov_b32 v8, 0
  v_mov_b32 v9, 0
  v_mov_b32 v10, 0
  v_mov_b32 v11, 0
  v_mov_b32 v12, 0x3f803f80
  s_add_u32 m0, s25, 32768
  s_mul_i32 s23, s17, 128
  s_add_u32 s23, s23, s69
  buffer_load_dwordx4 v2, s[36:39], s23 offen lds
  s_add_u32 m0, s25, 33792
  s_nop 0
  buffer_load_dwordx4 v3, s[36:39], s23 offen lds
  s_add_u32 m0, s68, 49152
  s_mul_i32 s24, s17, 229376
  s_add_u32 s24, s24, s70
  buffer_load_dwordx4 v4, s[40:43], s24 offen lds
  s_add_u32 m0, s68, 57344
  s_nop 0
  buffer_load_dwordx4 v4, s[44:47], s24 offen lds
  s_waitcnt vmcnt(4) lgkmcnt(0)
  s_barrier
  ds_read_b64_tr_b16 v[192:193], v244 offset:16384
  ds_read_b64_tr_b16 v[194:195], v244 offset:16640
  ds_read_b128 v[16:19], v248 offset:0
  ds_read_b64_tr_b16 v[196:197], v244 offset:24576
  ds_read_b64_tr_b16 v[198:199], v244 offset:24832
  ds_read_b64_tr_b16 v[200:201], v245 offset:16384
  ds_read_b64_tr_b16 v[202:203], v245 offset:16640
  ds_read_b128 v[20:23], v249 offset:0
  ds_read_b64_tr_b16 v[204:205], v245 offset:24576
  ds_read_b64_tr_b16 v[206:207], v245 offset:24832
  s_waitcnt lgkmcnt(7)
  v_mfma_f32_32x32x16_bf16 v[128:143], v[192:195], v[16:19], 0
  ds_read_b64_tr_b16 v[208:209], v246 offset:16384
  ds_read_b64_tr_b16 v[210:211], v246 offset:16640
  ds_read_b128 v[24:27], v250 offset:0
  v_mfma_f32_16x16x32_bf16 v[216:219], v[232:235], v[192:195], 0
  s_add_u32 m0, s25, 65536
  s_mul_i32 s23, s18, 128
  s_add_u32 s23, s23, s69
  buffer_load_dwordx4 v2, s[36:39], s23 offen lds
  s_waitcnt lgkmcnt(8)
  v_mfma_f32_32x32x16_bf16 v[144:159], v[196:199], v[16:19], 0
  ds_read_b64_tr_b16 v[212:213], v246 offset:24576
  ds_read_b64_tr_b16 v[214:215], v246 offset:24832
  v_mfma_f32_16x16x32_bf16 v[220:223], v[232:235], v[196:199], 0
  s_add_u32 m0, s25, 66560
  s_nop 0
  buffer_load_dwordx4 v3, s[36:39], s23 offen lds
  v_lshlrev_b32 v12, 16, v16
  v_and_b32 v13, s82, v16
  v_add_f32 v8, v8, v12
  v_add_f32 v9, v9, v13
  v_fmac_f32 v10, v12, v12
  v_fmac_f32 v11, v13, v13
  s_waitcnt lgkmcnt(7)
  v_mfma_f32_32x32x16_bf16 v[128:143], v[200:203], v[20:23], v[128:143]
  ds_read_b64_tr_b16 v[192:193], v247 offset:16384
  ds_read_b64_tr_b16 v[194:195], v247 offset:16640
  ds_read_b128 v[28:31], v251 offset:0
  s_add_u32 m0, s68, 81920
  s_mul_i32 s24, s18, 229376
  s_add_u32 s24, s24, s70
  buffer_load_dwordx4 v4, s[40:43], s24 offen lds
  v_lshlrev_b32 v14, 16, v17
  v_and_b32 v15, s82, v17
  v_add_f32 v8, v8, v14
  v_add_f32 v9, v9, v15
  v_fmac_f32 v10, v14, v14
  v_fmac_f32 v11, v15, v15
  s_waitcnt lgkmcnt(8)
  v_mfma_f32_32x32x16_bf16 v[144:159], v[204:207], v[20:23], v[144:159]
  ds_read_b64_tr_b16 v[196:197], v247 offset:24576
  ds_read_b64_tr_b16 v[198:199], v247 offset:24832
  s_add_u32 m0, s68, 90112
  s_nop 0
  buffer_load_dwordx4 v4, s[44:47], s24 offen lds
  v_lshlrev_b32 v12, 16, v18
  v_and_b32 v13, s82, v18
  v_add_f32 v8, v8, v12
  v_add_f32 v9, v9, v13
  v_fmac_f32 v10, v12, v12
  v_fmac_f32 v11, v13, v13
  s_waitcnt lgkmcnt(7)
  v_mfma_f32_32x32x16_bf16 v[128:143], v[208:211], v[24:27], v[128:143]
  s_waitcnt vmcnt(4)
  s_barrier
  ds_read_b64_tr_b16 v[200:201], v244 offset:49152
  ds_read_b64_tr_b16 v[202:203], v244 offset:49408
  ds_read_b128 v[32:35], v248 offset:32768
  v_lshlrev_b32 v14, 16, v19
  v_and_b32 v15, s82, v19
  v_add_f32 v8, v8, v14
  v_add_f32 v9, v9, v15
  v_fmac_f32 v10, v14, v14
  v_fmac_f32 v11, v15, v15
  s_waitcnt lgkmcnt(8)
  v_mfma_f32_32x32x16_bf16 v[144:159], v[212:215], v[24:27], v[144:159]
  ds_read_b64_tr_b16 v[204:205], v244 offset:57344
  ds_read_b64_tr_b16 v[206:207], v244 offset:57600
  s_add_u32 m0, s68, 98304
  s_mul_i32 s23, s16, s74
  s_add_u32 s23, s23, s71
  buffer_load_dwordx4 v5, s[48:51], s23 offen lds
  v_lshlrev_b32 v12, 16, v20
  v_and_b32 v13, s82, v20
  v_add_f32 v8, v8, v12
  v_add_f32 v9, v9, v13
  v_fmac_f32 v10, v12, v12
  v_fmac_f32 v11, v13, v13
  s_waitcnt lgkmcnt(7)
  v_mfma_f32_32x32x16_bf16 v[128:143], v[192:195], v[28:31], v[128:143]
  ds_read_b64_tr_b16 v[208:209], v245 offset:49152
  ds_read_b64_tr_b16 v[210:211], v245 offset:49408
  ds_read_b128 v[36:39], v249 offset:32768
  s_add_u32 m0, s68, 106496
  s_mul_i32 s24, s16, s74
  s_add_u32 s24, s24, s72
  buffer_load_dwordx4 v5, s[52:55], s24 offen lds
  v_lshlrev_b32 v14, 16, v21
  v_and_b32 v15, s82, v21
  v_add_f32 v8, v8, v14
  v_add_f32 v9, v9, v15
  v_fmac_f32 v10, v14, v14
  v_fmac_f32 v11, v15, v15
  s_waitcnt lgkmcnt(8)
  v_mfma_f32_32x32x16_bf16 v[144:159], v[196:199], v[28:31], v[144:159]
  ds_read_b64_tr_b16 v[212:213], v245 offset:57344
  ds_read_b64_tr_b16 v[214:215], v245 offset:57600
  s_add_u32 m0, s25, 114688
  s_mul_i32 s23, s19, 128
  s_add_u32 s23, s23, s69
  buffer_load_dwordx4 v2, s[36:39], s23 offen lds
  v_lshlrev_b32 v12, 16, v22
  v_and_b32 v13, s82, v22
  v_add_f32 v8, v8, v12
  v_add_f32 v9, v9, v13
  v_fmac_f32 v10, v12, v12
  v_fmac_f32 v11, v13, v13
  s_waitcnt lgkmcnt(7)
  v_mfma_f32_32x32x16_bf16 v[128:143], v[200:203], v[32:35], v[128:143]
  ds_read_b64_tr_b16 v[192:193], v246 offset:49152
  ds_read_b64_tr_b16 v[194:195], v246 offset:49408
  ds_read_b128 v[40:43], v250 offset:32768
  v_mfma_f32_16x16x32_bf16 v[216:219], v[232:235], v[200:203], v[216:219]
  s_add_u32 m0, s25, 115712
  s_nop 0
  buffer_load_dwordx4 v3, s[36:39], s23 offen lds
  v_lshlrev_b32 v14, 16, v23
  v_and_b32 v15, s82, v23
  v_add_f32 v8, v8, v14
  v_add_f32 v9, v9, v15
  v_fmac_f32 v10, v14, v14
  v_fmac_f32 v11, v15, v15
  s_waitcnt lgkmcnt(8)
  v_mfma_f32_32x32x16_bf16 v[144:159], v[204:207], v[32:35], v[144:159]
  ds_read_b64_tr_b16 v[196:197], v246 offset:57344
  ds_read_b64_tr_b16 v[198:199], v246 offset:57600
  v_mfma_f32_16x16x32_bf16 v[220:223], v[232:235], v[204:207], v[220:223]
  s_add_u32 m0, s68, 131072
  s_mul_i32 s24, s19, 229376
  s_add_u32 s24, s24, s70
  buffer_load_dwordx4 v4, s[40:43], s24 offen lds
  v_lshlrev_b32 v12, 16, v32
  v_and_b32 v13, s82, v32
  v_add_f32 v8, v8, v12
  v_add_f32 v9, v9, v13
  v_fmac_f32 v10, v12, v12
  v_fmac_f32 v11, v13, v13
  s_waitcnt lgkmcnt(7)
  v_mfma_f32_32x32x16_bf16 v[128:143], v[208:211], v[36:39], v[128:143]
  ds_read_b64_tr_b16 v[200:201], v247 offset:49152
  ds_read_b64_tr_b16 v[202:203], v247 offset:49408
  ds_read_b128 v[44:47], v251 offset:32768
  s_add_u32 m0, s68, 139264
  s_nop 0
  buffer_load_dwordx4 v4, s[44:47], s24 offen lds
  v_lshlrev_b32 v14, 16, v33
  v_and_b32 v15, s82, v33
  v_add_f32 v8, v8, v14
  v_add_f32 v9, v9, v15
  v_fmac_f32 v10, v14, v14
  v_fmac_f32 v11, v15, v15
  s_waitcnt lgkmcnt(8)
  v_mfma_f32_32x32x16_bf16 v[144:159], v[212:215], v[36:39], v[144:159]
  ds_read_b64_tr_b16 v[204:205], v247 offset:57344
  ds_read_b64_tr_b16 v[206:207], v247 offset:57600
  v_lshlrev_b32 v12, 16, v34
  v_and_b32 v13, s82, v34
  v_add_f32 v8, v8, v12
  v_add_f32 v9, v9, v13
  v_fmac_f32 v10, v12, v12
  v_fmac_f32 v11, v13, v13
  s_waitcnt lgkmcnt(7)
  v_mfma_f32_32x32x16_bf16 v[128:143], v[192:195], v[40:43], v[128:143]
  s_waitcnt vmcnt(6)
  s_barrier
  v_add_u32 v244, 65536, v244
  v_add_u32 v245, 65536, v245
  v_add_u32 v246, 65536, v246
  v_add_u32 v247, 65536, v247
  ds_read_b64_tr_b16 v[208:209], v244 offset:16384
  ds_read_b64_tr_b16 v[210:211], v244 offset:16640
  v_add_u32 v248, 65536, v248
  v_add_u32 v249, 65536, v249
  v_add_u32 v250, 65536, v250
  v_add_u32 v251, 65536, v251
  ds_read_b128 v[48:51], v248 offset:0
  v_lshlrev_b32 v14, 16, v35
  v_and_b32 v15, s82, v35
  v_add_f32 v8, v8, v14
  v_add_f32 v9, v9, v15
  v_fmac_f32 v10, v14, v14
  v_fmac_f32 v11, v15, v15
  s_waitcnt lgkmcnt(8)
  v_mfma_f32_32x32x16_bf16 v[144:159], v[196:199], v[40:43], v[144:159]
  ds_read_b64_tr_b16 v[212:213], v244 offset:24576
  ds_read_b64_tr_b16 v[214:215], v244 offset:24832
  s_add_u32 m0, s68, 0
  s_mul_i32 s23, s17, s74
  s_add_u32 s23, s23, s71
  buffer_load_dwordx4 v5, s[48:51], s23 offen lds
  v_lshlrev_b32 v12, 16, v36
  v_and_b32 v13, s82, v36
  v_add_f32 v8, v8, v12
  v_add_f32 v9, v9, v13
  v_fmac_f32 v10, v12, v12
  v_fmac_f32 v11, v13, v13
  s_waitcnt lgkmcnt(7)
  v_mfma_f32_32x32x16_bf16 v[128:143], v[200:203], v[44:47], v[128:143]
  ds_read_b64_tr_b16 v[192:193], v245 offset:16384
  ds_read_b64_tr_b16 v[194:195], v245 offset:16640
  ds_read_b128 v[52:55], v249 offset:0
  s_add_u32 m0, s68, 8192
  s_mul_i32 s24, s17, s74
  s_add_u32 s24, s24, s72
  buffer_load_dwordx4 v5, s[52:55], s24 offen lds
  v_lshlrev_b32 v14, 16, v37
  v_and_b32 v15, s82, v37
  v_add_f32 v8, v8, v14
  v_add_f32 v9, v9, v15
  v_fmac_f32 v10, v14, v14
  v_fmac_f32 v11, v15, v15
  s_waitcnt lgkmcnt(8)
  v_mfma_f32_32x32x16_bf16 v[144:159], v[204:207], v[44:47], v[144:159]
  ds_read_b64_tr_b16 v[196:197], v245 offset:24576
  ds_read_b64_tr_b16 v[198:199], v245 offset:24832
  s_add_u32 m0, s25, 16384
  s_mul_i32 s23, s20, 128
  s_add_u32 s23, s23, s69
  buffer_load_dwordx4 v2, s[36:39], s23 offen lds
  v_lshlrev_b32 v12, 16, v38
  v_and_b32 v13, s82, v38
  v_add_f32 v8, v8, v12
  v_add_f32 v9, v9, v13
  v_fmac_f32 v10, v12, v12
  v_fmac_f32 v11, v13, v13
  s_waitcnt lgkmcnt(7)
  v_mfma_f32_32x32x16_bf16 v[128:143], v[208:211], v[48:51], v[128:143]
  ds_read_b64_tr_b16 v[200:201], v246 offset:16384
  ds_read_b64_tr_b16 v[202:203], v246 offset:16640
  ds_read_b128 v[56:59], v250 offset:0
  v_mfma_f32_16x16x32_bf16 v[216:219], v[232:235], v[208:211], v[216:219]
  s_add_u32 m0, s25, 17408
  s_nop 0
  buffer_load_dwordx4 v3, s[36:39], s23 offen lds
  v_lshlrev_b32 v14, 16, v39
  v_and_b32 v15, s82, v39
  v_add_f32 v8, v8, v14
  v_add_f32 v9, v9, v15
  v_fmac_f32 v10, v14, v14
  v_fmac_f32 v11, v15, v15
  s_waitcnt lgkmcnt(8)
  v_mfma_f32_32x32x16_bf16 v[144:159], v[212:215], v[48:51], v[144:159]
  ds_read_b64_tr_b16 v[204:205], v246 offset:24576
  ds_read_b64_tr_b16 v[206:207], v246 offset:24832
  v_mfma_f32_16x16x32_bf16 v[220:223], v[232:235], v[212:215], v[220:223]
  v_lshlrev_b32 v12, 16, v48
  v_and_b32 v13, s82, v48
  v_add_f32 v8, v8, v12
  v_add_f32 v9, v9, v13
  v_fmac_f32 v10, v12, v12
  v_fmac_f32 v11, v13, v13
  s_waitcnt lgkmcnt(7)
  v_mfma_f32_32x32x16_bf16 v[128:143], v[192:195], v[52:55], v[128:143]
  ds_read_b64_tr_b16 v[208:209], v247 offset:16384
  ds_read_b64_tr_b16 v[210:211], v247 offset:16640
  ds_read_b128 v[60:63], v251 offset:0
  v_lshlrev_b32 v14, 16, v49
  v_and_b32 v15, s82, v49
  v_add_f32 v8, v8, v14
  v_add_f32 v9, v9, v15
  v_fmac_f32 v10, v14, v14
  v_fmac_f32 v11, v15, v15
  s_waitcnt lgkmcnt(8)
  v_mfma_f32_32x32x16_bf16 v[144:159], v[196:199], v[52:55], v[144:159]
  ds_read_b64_tr_b16 v[212:213], v247 offset:24576
  ds_read_b64_tr_b16 v[214:215], v247 offset:24832
  v_lshlrev_b32 v12, 16, v50
  v_and_b32 v13, s82, v50
  v_add_f32 v8, v8, v12
  v_add_f32 v9, v9, v13
  v_fmac_f32 v10, v12, v12
  v_fmac_f32 v11, v13, v13
  s_waitcnt lgkmcnt(7)
  v_mfma_f32_32x32x16_bf16 v[128:143], v[200:203], v[56:59], v[128:143]
  s_waitcnt vmcnt(8)
  s_barrier
  v_add_u32 v244, s90, v244
  v_add_u32 v245, s90, v245
  v_add_u32 v246, s90, v246
  v_add_u32 v247, s90, v247
  ds_read_b64_tr_b16 v[192:193], v244 offset:32768
  ds_read_b64_tr_b16 v[194:195], v244 offset:33024
  v_lshlrev_b32 v14, 16, v51
  v_and_b32 v15, s82, v51
  v_add_f32 v8, v8, v14
  v_add_f32 v9, v9, v15
  v_fmac_f32 v10, v14, v14
  v_fmac_f32 v11, v15, v15
  s_waitcnt lgkmcnt(7)
  v_mfma_f32_32x32x16_bf16 v[144:159], v[204:207], v[56:59], v[144:159]
  ds_read_b64_tr_b16 v[196:197], v244 offset:40960
  ds_read_b64_tr_b16 v[198:199], v244 offset:41216
  s_add_u32 m0, s68, 32768
  s_mul_i32 s24, s20, 229376
  s_add_u32 s24, s24, s70
  buffer_load_dwordx4 v4, s[40:43], s24 offen lds
  v_lshlrev_b32 v12, 16, v52
  v_and_b32 v13, s82, v52
  v_add_f32 v8, v8, v12
  v_add_f32 v9, v9, v13
  v_fmac_f32 v10, v12, v12
  v_fmac_f32 v11, v13, v13
  s_waitcnt lgkmcnt(6)
  v_mfma_f32_32x32x16_bf16 v[128:143], v[208:211], v[60:63], v[128:143]
  ds_read_b64_tr_b16 v[200:201], v245 offset:32768
  ds_read_b64_tr_b16 v[202:203], v245 offset:33024
  s_add_u32 m0, s68, 40960
  s_nop 0
  buffer_load_dwordx4 v4, s[44:47], s24 offen lds
  v_lshlrev_b32 v14, 16, v53
  v_and_b32 v15, s82, v53
  v_add_f32 v8, v8, v14
  v_add_f32 v9, v9, v15
  v_fmac_f32 v10, v14, v14
  v_fmac_f32 v11, v15, v15
  s_waitcnt lgkmcnt(6)
  v_mfma_f32_32x32x16_bf16 v[144:159], v[212:215], v[60:63], v[144:159]
  ds_read_b64_tr_b16 v[204:205], v245 offset:40960
  ds_read_b64_tr_b16 v[206:207], v245 offset:41216
  v_lshlrev_b32 v12, 16, v54
  v_and_b32 v13, s82, v54
  v_add_f32 v8, v8, v12
  v_add_f32 v9, v9, v13
  v_fmac_f32 v10, v12, v12
  v_fmac_f32 v11, v13, v13
  s_waitcnt lgkmcnt(6)
  v_mfma_f32_32x32x16_bf16 v[160:175], v[192:195], v[16:19], 0
  ds_read_b64_tr_b16 v[208:209], v246 offset:32768
  ds_read_b64_tr_b16 v[210:211], v246 offset:33024
  v_mfma_f32_16x16x32_bf16 v[224:227], v[232:235], v[192:195], 0
  v_lshlrev_b32 v14, 16, v55
  v_and_b32 v15, s82, v55
  v_add_f32 v8, v8, v14
  v_add_f32 v9, v9, v15
  v_fmac_f32 v10, v14, v14
  v_fmac_f32 v11, v15, v15
  s_waitcnt lgkmcnt(6)
  v_mfma_f32_32x32x16_bf16 v[176:191], v[196:199], v[16:19], 0
  ds_read_b64_tr_b16 v[212:213], v246 offset:40960
  ds_read_b64_tr_b16 v[214:215], v246 offset:41216
  v_mfma_f32_16x16x32_bf16 v[228:231], v[232:235], v[196:199], 0
  s_waitcnt lgkmcnt(6)
  v_mfma_f32_32x32x16_bf16 v[160:175], v[200:203], v[20:23], v[160:175]
  ds_read_b64_tr_b16 v[192:193], v247 offset:32768
  ds_read_b64_tr_b16 v[194:195], v247 offset:33024
  s_waitcnt lgkmcnt(6)
  v_mfma_f32_32x32x16_bf16 v[176:191], v[204:207], v[20:23], v[176:191]
  ds_read_b64_tr_b16 v[196:197], v247 offset:40960
  ds_read_b64_tr_b16 v[198:199], v247 offset:41216
  s_waitcnt lgkmcnt(6)
  v_mfma_f32_32x32x16_bf16 v[160:175], v[208:211], v[24:27], v[160:175]
  s_waitcnt vmcnt(6)
  s_barrier
  v_add_u32 v244, 65536, v244
  v_add_u32 v245, 65536, v245
  v_add_u32 v246, 65536, v246
  v_add_u32 v247, 65536, v247
  v_subrev_u32 v244, s90, v244
  v_subrev_u32 v245, s90, v245
  v_subrev_u32 v246, s90, v246
  v_subrev_u32 v247, s90, v247
  ds_read_b64_tr_b16 v[200:201], v244 offset:0
  ds_read_b64_tr_b16 v[202:203], v244 offset:256
  ds_read_b128 v[64:67], v248 offset:49152
  s_waitcnt lgkmcnt(7)
  v_mfma_f32_32x32x16_bf16 v[176:191], v[212:215], v[24:27], v[176:191]
  ds_read_b64_tr_b16 v[204:205], v244 offset:8192
  ds_read_b64_tr_b16 v[206:207], v244 offset:8448
  s_add_u32 m0, s68, 49152
  s_mul_i32 s23, s18, s74
  s_add_u32 s23, s23, s71
  buffer_load_dwordx4 v5, s[48:51], s23 offen lds
  s_waitcnt lgkmcnt(7)
  v_mfma_f32_32x32x16_bf16 v[160:175], v[192:195], v[28:31], v[160:175]
  ds_read_b64_tr_b16 v[208:209], v245 offset:0
  ds_read_b64_tr_b16 v[210:211], v245 offset:256
  ds_read_b128 v[68:71], v249 offset:49152
  s_add_u32 m0, s68, 57344
  s_mul_i32 s24, s18, s74
  s_add_u32 s24, s24, s72
  buffer_load_dwordx4 v5, s[52:55], s24 offen lds
  s_waitcnt lgkmcnt(8)
  v_mfma_f32_32x32x16_bf16 v[176:191], v[196:199], v[28:31], v[176:191]
  ds_read_b64_tr_b16 v[212:213], v245 offset:8192
  ds_read_b64_tr_b16 v[214:215], v245 offset:8448
  s_add_u32 m0, s68, 147456
  s_nop 0
  buffer_load_dwordx4 v7, s[60:63], s26 offen lds
  s_waitcnt lgkmcnt(7)
  v_mfma_f32_32x32x16_bf16 v[128:143], v[200:203], v[64:67], v[128:143]
  ds_read_b64_tr_b16 v[192:193], v246 offset:0
  ds_read_b64_tr_b16 v[194:195], v246 offset:256
  ds_read_b128 v[72:75], v250 offset:49152
  v_mfma_f32_16x16x32_bf16 v[216:219], v[232:235], v[200:203], v[216:219]
  s_add_u32 m0, s25, 65536
  s_mul_i32 s23, s21, 128
  s_add_u32 s23, s23, s69
  buffer_load_dwordx4 v2, s[36:39], s23 offen lds
  s_waitcnt lgkmcnt(8)
  v_mfma_f32_32x32x16_bf16 v[144:159], v[204:207], v[64:67], v[144:159]
  ds_read_b64_tr_b16 v[196:197], v246 offset:8192
  ds_read_b64_tr_b16 v[198:199], v246 offset:8448
  v_mfma_f32_16x16x32_bf16 v[220:223], v[232:235], v[204:207], v[220:223]
  v_lshlrev_b32 v12, 16, v64
  v_and_b32 v13, s82, v64
  v_add_f32 v8, v8, v12
  v_add_f32 v9, v9, v13
  v_fmac_f32 v10, v12, v12
  v_fmac_f32 v11, v13, v13
  s_waitcnt lgkmcnt(7)
  v_mfma_f32_32x32x16_bf16 v[128:143], v[208:211], v[68:71], v[128:143]
  ds_read_b64_tr_b16 v[200:201], v247 offset:0
  ds_read_b64_tr_b16 v[202:203], v247 offset:256
  ds_read_b128 v[76:79], v251 offset:49152
  v_lshlrev_b32 v14, 16, v65
  v_and_b32 v15, s82, v65
  v_add_f32 v8, v8, v14
  v_add_f32 v9, v9, v15
  v_fmac_f32 v10, v14, v14
  v_fmac_f32 v11, v15, v15
  s_waitcnt lgkmcnt(8)
  v_mfma_f32_32x32x16_bf16 v[144:159], v[212:215], v[68:71], v[144:159]
  ds_read_b64_tr_b16 v[204:205], v247 offset:8192
  ds_read_b64_tr_b16 v[206:207], v247 offset:8448
  v_lshlrev_b32 v12, 16, v66
  v_and_b32 v13, s82, v66
  v_add_f32 v8, v8, v12
  v_add_f32 v9, v9, v13
  v_fmac_f32 v10, v12, v12
  v_fmac_f32 v11, v13, v13
  s_waitcnt lgkmcnt(7)
  v_mfma_f32_32x32x16_bf16 v[128:143], v[192:195], v[72:75], v[128:143]
  s_waitcnt vmcnt(8)
  s_barrier
  s_lshl_b32 s9, s2, 13
  s_add_u32 s9, s9, s68
  s_add_u32 s9, s9, 16777216
  v_mov_b32 v124, -1
  v_mov_b32 v125, -1
  v_mov_b32 v126, -1
  v_mov_b32 v127, -1
  buffer_store_dwordx4 v[124:127], v1, s[64:67], s9 offen sc1
  v_add_u32 v244, 4294836224, v244
  v_add_u32 v245, 4294836224, v245
  v_add_u32 v246, 4294836224, v246
  v_add_u32 v247, 4294836224, v247
  v_add_u32 v244, s90, v244
  v_add_u32 v245, s90, v245
  v_add_u32 v246, s90, v246
  v_add_u32 v247, s90, v247
  ds_read_b64_tr_b16 v[208:209], v244 offset:0
  ds_read_b64_tr_b16 v[210:211], v244 offset:256
  v_lshlrev_b32 v14, 16, v67
  v_and_b32 v15, s82, v67
  v_add_f32 v8, v8, v14
  v_add_f32 v9, v9, v15
  v_fmac_f32 v10, v14, v14
  v_fmac_f32 v11, v15, v15
  s_waitcnt lgkmcnt(7)
  v_mfma_f32_32x32x16_bf16 v[144:159], v[196:199], v[72:75], v[144:159]
  ds_read_b64_tr_b16 v[212:213], v244 offset:8192
  ds_read_b64_tr_b16 v[214:215], v244 offset:8448
  s_add_u32 m0, s25, 66560
  s_nop 0
  buffer_load_dwordx4 v3, s[36:39], s23 offen lds
  v_lshlrev_b32 v12, 16, v68
  v_and_b32 v13, s82, v68
  v_add_f32 v8, v8, v12
  v_add_f32 v9, v9, v13
  v_fmac_f32 v10, v12, v12
  v_fmac_f32 v11, v13, v13
  s_waitcnt lgkmcnt(6)
  v_mfma_f32_32x32x16_bf16 v[128:143], v[200:203], v[76:79], v[128:143]
  ds_read_b64_tr_b16 v[192:193], v245 offset:0
  ds_read_b64_tr_b16 v[194:195], v245 offset:256
  s_add_u32 m0, s68, 81920
  s_mul_i32 s24, s21, 229376
  s_add_u32 s24, s24, s70
  buffer_load_dwordx4 v4, s[40:43], s24 offen lds
  v_lshlrev_b32 v14, 16, v69
  v_and_b32 v15, s82, v69
  v_add_f32 v8, v8, v14
  v_add_f32 v9, v9, v15
  v_fmac_f32 v10, v14, v14
  v_fmac_f32 v11, v15, v15
  s_waitcnt lgkmcnt(6)
  v_mfma_f32_32x32x16_bf16 v[144:159], v[204:207], v[76:79], v[144:159]
  ds_read_b64_tr_b16 v[196:197], v245 offset:8192
  ds_read_b64_tr_b16 v[198:199], v245 offset:8448
  v_lshlrev_b32 v12, 16, v70
  v_and_b32 v13, s82, v70
  v_add_f32 v8, v8, v12
  v_add_f32 v9, v9, v13
  v_fmac_f32 v10, v12, v12
  v_fmac_f32 v11, v13, v13
  s_waitcnt lgkmcnt(6)
  v_mfma_f32_32x32x16_bf16 v[160:175], v[208:211], v[32:35], v[160:175]
  ds_read_b64_tr_b16 v[200:201], v246 offset:0
  ds_read_b64_tr_b16 v[202:203], v246 offset:256
  v_mfma_f32_16x16x32_bf16 v[224:227], v[232:235], v[208:211], v[224:227]
  v_lshlrev_b32 v14, 16, v71
  v_and_b32 v15, s82, v71
  v_add_f32 v8, v8, v14
  v_add_f32 v9, v9, v15
  v_fmac_f32 v10, v14, v14
  v_fmac_f32 v11, v15, v15
  s_waitcnt lgkmcnt(6)
  v_mfma_f32_32x32x16_bf16 v[176:191], v[212:215], v[32:35], v[176:191]
  ds_read_b64_tr_b16 v[204:205], v246 offset:8192
  ds_read_b64_tr_b16 v[206:207], v246 offset:8448
  v_mfma_f32_16x16x32_bf16 v[228:231], v[232:235], v[212:215], v[228:231]
  s_waitcnt lgkmcnt(6)
  v_mfma_f32_32x32x16_bf16 v[160:175], v[192:195], v[36:39], v[160:175]
  ds_read_b64_tr_b16 v[208:209], v247 offset:0
  ds_read_b64_tr_b16 v[210:211], v247 offset:256
  s_waitcnt lgkmcnt(6)
  v_mfma_f32_32x32x16_bf16 v[176:191], v[196:199], v[36:39], v[176:191]
  ds_read_b64_tr_b16 v[212:213], v247 offset:8192
  ds_read_b64_tr_b16 v[214:215], v247 offset:8448
  s_waitcnt lgkmcnt(6)
  v_mfma_f32_32x32x16_bf16 v[160:175], v[200:203], v[40:43], v[160:175]
  s_waitcnt vmcnt(7)
  s_barrier
  v_subrev_u32 v244, s90, v244
  v_subrev_u32 v245, s90, v245
  v_subrev_u32 v246, s90, v246
  v_subrev_u32 v247, s90, v247
  ds_read_b64_tr_b16 v[192:193], v244 offset:32768
  ds_read_b64_tr_b16 v[194:195], v244 offset:33024
  v_add_u32 v248, 4294901760, v248
  v_add_u32 v249, 4294901760, v249
  v_add_u32 v250, 4294901760, v250
  v_add_u32 v251, 4294901760, v251
  ds_read_b128 v[80:83], v248 offset:16384
  s_waitcnt lgkmcnt(7)
  v_mfma_f32_32x32x16_bf16 v[176:191], v[204:207], v[40:43], v[176:191]
  ds_read_b64_tr_b16 v[196:197], v244 offset:40960
  ds_read_b64_tr_b16 v[198:199], v244 offset:41216
  s_add_u32 m0, s68, 90112
  s_nop 0
  buffer_load_dwordx4 v4, s[44:47], s24 offen lds
  s_waitcnt lgkmcnt(7)
  v_mfma_f32_32x32x16_bf16 v[160:175], v[208:211], v[44:47], v[160:175]
  ds_read_b64_tr_b16 v[200:201], v245 offset:32768
  ds_read_b64_tr_b16 v[202:203], v245 offset:33024
  ds_read_b128 v[84:87], v249 offset:16384
  s_add_u32 m0, s68, 98304
  s_mul_i32 s23, s19, s74
  s_add_u32 s23, s23, s71
  buffer_load_dwordx4 v5, s[48:51], s23 offen lds
  s_waitcnt lgkmcnt(8)
  v_mfma_f32_32x32x16_bf16 v[176:191], v[212:215], v[44:47], v[176:191]
  ds_read_b64_tr_b16 v[204:205], v245 offset:40960
  ds_read_b64_tr_b16 v[206:207], v245 offset:41216
  s_add_u32 m0, s68, 106496
  s_mul_i32 s24, s19, s74
  s_add_u32 s24, s24, s72
  buffer_load_dwordx4 v5, s[52:55], s24 offen lds
  s_waitcnt lgkmcnt(7)
  v_mfma_f32_32x32x16_bf16 v[128:143], v[192:195], v[80:83], v[128:143]
  ds_read_b64_tr_b16 v[208:209], v246 offset:32768
  ds_read_b64_tr_b16 v[210:211], v246 offset:33024
  ds_read_b128 v[88:91], v250 offset:16384
  v_mfma_f32_16x16x32_bf16 v[216:219], v[232:235], v[192:195], v[216:219]
  s_add_u32 m0, s25, 114688
  s_mul_i32 s23, s22, 128
  s_add_u32 s23, s23, s69
  buffer_load_dwordx4 v2, s[36:39], s23 offen lds
  s_waitcnt lgkmcnt(8)
  v_mfma_f32_32x32x16_bf16 v[144:159], v[196:199], v[80:83], v[144:159]
  ds_read_b64_tr_b16 v[212:213], v246 offset:40960
  ds_read_b64_tr_b16 v[214:215], v246 offset:41216
  v_mfma_f32_16x16x32_bf16 v[220:223], v[232:235], v[196:199], v[220:223]
  v_lshlrev_b32 v12, 16, v80
  v_and_b32 v13, s82, v80
  v_add_f32 v8, v8, v12
  v_add_f32 v9, v9, v13
  v_fmac_f32 v10, v12, v12
  v_fmac_f32 v11, v13, v13
  s_waitcnt lgkmcnt(7)
  v_mfma_f32_32x32x16_bf16 v[128:143], v[200:203], v[84:87], v[128:143]
  ds_read_b64_tr_b16 v[192:193], v247 offset:32768
  ds_read_b64_tr_b16 v[194:195], v247 offset:33024
  ds_read_b128 v[92:95], v251 offset:16384
  v_lshlrev_b32 v14, 16, v81
  v_and_b32 v15, s82, v81
  v_add_f32 v8, v8, v14
  v_add_f32 v9, v9, v15
  v_fmac_f32 v10, v14, v14
  v_fmac_f32 v11, v15, v15
  s_waitcnt lgkmcnt(8)
  v_mfma_f32_32x32x16_bf16 v[144:159], v[204:207], v[84:87], v[144:159]
  ds_read_b64_tr_b16 v[196:197], v247 offset:40960
  ds_read_b64_tr_b16 v[198:199], v247 offset:41216
  v_lshlrev_b32 v12, 16, v82
  v_and_b32 v13, s82, v82
  v_add_f32 v8, v8, v12
  v_add_f32 v9, v9, v13
  v_fmac_f32 v10, v12, v12
  v_fmac_f32 v11, v13, v13
  s_waitcnt lgkmcnt(7)
  v_mfma_f32_32x32x16_bf16 v[128:143], v[208:211], v[88:91], v[128:143]
  s_waitcnt vmcnt(9)
  s_barrier
  v_add_u32 v244, s90, v244
  v_add_u32 v245, s90, v245
  v_add_u32 v246, s90, v246
  v_add_u32 v247, s90, v247
  ds_read_b64_tr_b16 v[200:201], v244 offset:49152
  ds_read_b64_tr_b16 v[202:203], v244 offset:49408
  v_lshlrev_b32 v14, 16, v83
  v_and_b32 v15, s82, v83
  v_add_f32 v8, v8, v14
  v_add_f32 v9, v9, v15
  v_fmac_f32 v10, v14, v14
  v_fmac_f32 v11, v15, v15
  s_waitcnt lgkmcnt(7)
  v_mfma_f32_32x32x16_bf16 v[144:159], v[212:215], v[88:91], v[144:159]
  ds_read_b64_tr_b16 v[204:205], v244 offset:57344
  ds_read_b64_tr_b16 v[206:207], v244 offset:57600
  s_add_u32 m0, s25, 115712
  s_nop 0
  buffer_load_dwordx4 v3, s[36:39], s23 offen lds
  v_lshlrev_b32 v12, 16, v84
  v_and_b32 v13, s82, v84
  v_add_f32 v8, v8, v12
  v_add_f32 v9, v9, v13
  v_fmac_f32 v10, v12, v12
  v_fmac_f32 v11, v13, v13
  s_waitcnt lgkmcnt(6)
  v_mfma_f32_32x32x16_bf16 v[128:143], v[192:195], v[92:95], v[128:143]
  ds_read_b64_tr_b16 v[208:209], v245 offset:49152
  ds_read_b64_tr_b16 v[210:211], v245 offset:49408
  s_add_u32 m0, s68, 131072
  s_mul_i32 s24, s22, 229376
  s_add_u32 s24, s24, s70
  buffer_load_dwordx4 v4, s[40:43], s24 offen lds
  v_lshlrev_b32 v14, 16, v85
  v_and_b32 v15, s82, v85
  v_add_f32 v8, v8, v14
  v_add_f32 v9, v9, v15
  v_fmac_f32 v10, v14, v14
  v_fmac_f32 v11, v15, v15
  s_waitcnt lgkmcnt(6)
  v_mfma_f32_32x32x16_bf16 v[144:159], v[196:199], v[92:95], v[144:159]
  ds_read_b64_tr_b16 v[212:213], v245 offset:57344
  ds_read_b64_tr_b16 v[214:215], v245 offset:57600
  v_lshlrev_b32 v12, 16, v86
  v_and_b32 v13, s82, v86
  v_add_f32 v8, v8, v12
  v_add_f32 v9, v9, v13
  v_fmac_f32 v10, v12, v12
  v_fmac_f32 v11, v13, v13
  s_waitcnt lgkmcnt(6)
  v_mfma_f32_32x32x16_bf16 v[160:175], v[200:203], v[48:51], v[160:175]
  ds_read_b64_tr_b16 v[192:193], v246 offset:49152
  ds_read_b64_tr_b16 v[194:195], v246 offset:49408
  v_mfma_f32_16x16x32_bf16 v[224:227], v[232:235], v[200:203], v[224:227]
  v_lshlrev_b32 v14, 16, v87
  v_and_b32 v15, s82, v87
  v_add_f32 v8, v8, v14
  v_add_f32 v9, v9, v15
  v_fmac_f32 v10, v14, v14
  v_fmac_f32 v11, v15, v15
  s_waitcnt lgkmcnt(6)
  v_mfma_f32_32x32x16_bf16 v[176:191], v[204:207], v[48:51], v[176:191]
  ds_read_b64_tr_b16 v[196:197], v246 offset:57344
  ds_read_b64_tr_b16 v[198:199], v246 offset:57600
  v_mfma_f32_16x16x32_bf16 v[228:231], v[232:235], v[204:207], v[228:231]
  s_waitcnt lgkmcnt(6)
  v_mfma_f32_32x32x16_bf16 v[160:175], v[208:211], v[52:55], v[160:175]
  ds_read_b64_tr_b16 v[200:201], v247 offset:49152
  ds_read_b64_tr_b16 v[202:203], v247 offset:49408
  s_waitcnt lgkmcnt(6)
  v_mfma_f32_32x32x16_bf16 v[176:191], v[212:215], v[52:55], v[176:191]
  ds_read_b64_tr_b16 v[204:205], v247 offset:57344
  ds_read_b64_tr_b16 v[206:207], v247 offset:57600
  s_waitcnt lgkmcnt(6)
  v_mfma_f32_32x32x16_bf16 v[160:175], v[192:195], v[56:59], v[160:175]
  s_waitcnt vmcnt(5)
  s_barrier
  v_add_u32 v244, 65536, v244
  v_add_u32 v245, 65536, v245
  v_add_u32 v246, 65536, v246
  v_add_u32 v247, 65536, v247
  v_subrev_u32 v244, s90, v244
  v_subrev_u32 v245, s90, v245
  v_subrev_u32 v246, s90, v246
  v_subrev_u32 v247, s90, v247
  ds_read_b64_tr_b16 v[208:209], v244 offset:16384
  ds_read_b64_tr_b16 v[210:211], v244 offset:16640
  v_add_u32 v248, 65536, v248
  v_add_u32 v249, 65536, v249
  v_add_u32 v250, 65536, v250
  v_add_u32 v251, 65536, v251
  ds_read_b128 v[96:99], v248 offset:0
  s_waitcnt lgkmcnt(7)
  v_mfma_f32_32x32x16_bf16 v[176:191], v[196:199], v[56:59], v[176:191]
  ds_read_b64_tr_b16 v[212:213], v244 offset:24576
  ds_read_b64_tr_b16 v[214:215], v244 offset:24832
  s_add_u32 m0, s68, 139264
  s_nop 0
  buffer_load_dwordx4 v4, s[44:47], s24 offen lds
  s_waitcnt lgkmcnt(7)
  v_mfma_f32_32x32x16_bf16 v[160:175], v[200:203], v[60:63], v[160:175]
  ds_read_b64_tr_b16 v[192:193], v245 offset:16384
  ds_read_b64_tr_b16 v[194:195], v245 offset:16640
  ds_read_b128 v[100:103], v249 offset:0
  s_add_u32 m0, s68, 0
  s_mul_i32 s23, s20, s74
  s_add_u32 s23, s23, s71
  buffer_load_dwordx4 v5, s[48:51], s23 offen lds
  s_waitcnt lgkmcnt(8)
  v_mfma_f32_32x32x16_bf16 v[176:191], v[204:207], v[60:63], v[176:191]
  ds_read_b64_tr_b16 v[196:197], v245 offset:24576
  ds_read_b64_tr_b16 v[198:199], v245 offset:24832
  s_add_u32 m0, s68, 8192
  s_mul_i32 s24, s20, s74
  s_add_u32 s24, s24, s72
  buffer_load_dwordx4 v5, s[52:55], s24 offen lds
  s_waitcnt lgkmcnt(7)
  v_mfma_f32_32x32x16_bf16 v[128:143], v[208:211], v[96:99], v[128:143]
  s_waitcnt vmcnt(13)
  v_and_b32 v120, 255, v244
  v_lshrrev_b32 v7, 5, v0
  v_lshl_add_u32 v120, v7, 8, v120
  s_add_u32 s9, s68, 147456
  v_add_u32 v120, s9, v120
  ds_read_b64_tr_b16 v[116:117], v120
  ds_read_b64_tr_b16 v[118:119], v120 offset:512
  ds_read_b64_tr_b16 v[200:201], v246 offset:16384
  ds_read_b64_tr_b16 v[202:203], v246 offset:16640
  ds_read_b128 v[104:107], v250 offset:0
  v_mfma_f32_16x16x32_bf16 v[216:219], v[232:235], v[208:211], v[216:219]
  s_add_u32 m0, s68, 16384
  s_mul_i32 s23, s21, s74
  s_add_u32 s23, s23, s71
  buffer_load_dwordx4 v5, s[48:51], s23 offen lds
  s_waitcnt lgkmcnt(10)
  v_mfma_f32_32x32x16_bf16 v[144:159], v[212:215], v[96:99], v[144:159]
  ds_read_b64_tr_b16 v[204:205], v246 offset:24576
  ds_read_b64_tr_b16 v[206:207], v246 offset:24832
  v_mfma_f32_16x16x32_bf16 v[220:223], v[232:235], v[212:215], v[220:223]
  s_add_u32 m0, s68, 24576
  s_mul_i32 s24, s21, s74
  s_add_u32 s24, s24, s72
  buffer_load_dwordx4 v5, s[52:55], s24 offen lds
  v_lshlrev_b32 v12, 16, v96
  v_and_b32 v13, s82, v96
  v_add_f32 v8, v8, v12
  v_add_f32 v9, v9, v13
  v_fmac_f32 v10, v12, v12
  v_fmac_f32 v11, v13, v13
  s_waitcnt lgkmcnt(9)
  v_mfma_f32_32x32x16_bf16 v[128:143], v[192:195], v[100:103], v[128:143]
  s_waitcnt lgkmcnt(5)
  s_mov_b64 exec, s[80:81]
  v_mov_b32 v118, 0
  v_mov_b32 v119, 0
  s_mov_b64 exec, -1
  buffer_store_dwordx4 v[116:119], v1, s[64:67], s79 offen sc1
  ds_read_b64_tr_b16 v[208:209], v247 offset:16384
  ds_read_b64_tr_b16 v[210:211], v247 offset:16640
  ds_read_b128 v[108:111], v251 offset:0
  v_lshlrev_b32 v14, 16, v97
  v_and_b32 v15, s82, v97
  v_add_f32 v8, v8, v14
  v_add_f32 v9, v9, v15
  v_fmac_f32 v10, v14, v14
  v_fmac_f32 v11, v15, v15
  s_waitcnt lgkmcnt(10)
  v_mfma_f32_32x32x16_bf16 v[144:159], v[196:199], v[100:103], v[144:159]
  ds_read_b64_tr_b16 v[212:213], v247 offset:24576
  ds_read_b64_tr_b16 v[214:215], v247 offset:24832
  v_lshlrev_b32 v12, 16, v98
  v_and_b32 v13, s82, v98
  v_add_f32 v8, v8, v12
  v_add_f32 v9, v9, v13
  v_fmac_f32 v10, v12, v12
  v_fmac_f32 v11, v13, v13
  s_waitcnt lgkmcnt(7)
  v_mfma_f32_32x32x16_bf16 v[128:143], v[200:203], v[104:107], v[128:143]
  s_waitcnt vmcnt(9)
  s_barrier
  v_add_u32 v244, s90, v244
  v_add_u32 v245, s90, v245
  v_add_u32 v246, s90, v246
  v_add_u32 v247, s90, v247
  ds_read_b64_tr_b16 v[192:193], v244 offset:32768
  ds_read_b64_tr_b16 v[194:195], v244 offset:33024
  v_lshlrev_b32 v14, 16, v99
  v_and_b32 v15, s82, v99
  v_add_f32 v8, v8, v14
  v_add_f32 v9, v9, v15
  v_fmac_f32 v10, v14, v14
  v_fmac_f32 v11, v15, v15
  s_waitcnt lgkmcnt(7)
  v_mfma_f32_32x32x16_bf16 v[144:159], v[204:207], v[104:107], v[144:159]
  ds_read_b64_tr_b16 v[196:197], v244 offset:40960
  ds_read_b64_tr_b16 v[198:199], v244 offset:41216
  s_add_u32 m0, s68, 32768
  s_mul_i32 s23, s22, s74
  s_add_u32 s23, s23, s71
  buffer_load_dwordx4 v5, s[48:51], s23 offen lds
  v_lshlrev_b32 v12, 16, v100
  v_and_b32 v13, s82, v100
  v_add_f32 v8, v8, v12
  v_add_f32 v9, v9, v13
  v_fmac_f32 v10, v12, v12
  v_fmac_f32 v11, v13, v13
  s_waitcnt lgkmcnt(6)
  v_mfma_f32_32x32x16_bf16 v[128:143], v[208:211], v[108:111], v[128:143]
  ds_read_b64_tr_b16 v[200:201], v245 offset:32768
  ds_read_b64_tr_b16 v[202:203], v245 offset:33024
  s_add_u32 m0, s68, 40960
  s_mul_i32 s24, s22, s74
  s_add_u32 s24, s24, s72
  buffer_load_dwordx4 v5, s[52:55], s24 offen lds
  v_lshlrev_b32 v14, 16, v101
  v_and_b32 v15, s82, v101
  v_add_f32 v8, v8, v14
  v_add_f32 v9, v9, v15
  v_fmac_f32 v10, v14, v14
  v_fmac_f32 v11, v15, v15
  s_waitcnt lgkmcnt(6)
  v_mfma_f32_32x32x16_bf16 v[144:159], v[212:215], v[108:111], v[144:159]
  ds_read_b64_tr_b16 v[204:205], v245 offset:40960
  ds_read_b64_tr_b16 v[206:207], v245 offset:41216
  v_lshlrev_b32 v12, 16, v102
  v_and_b32 v13, s82, v102
  v_add_f32 v8, v8, v12
  v_add_f32 v9, v9, v13
  v_fmac_f32 v10, v12, v12
  v_fmac_f32 v11, v13, v13
  s_waitcnt lgkmcnt(6)
  v_mfma_f32_32x32x16_bf16 v[160:175], v[192:195], v[64:67], v[160:175]
  ds_read_b64_tr_b16 v[208:209], v246 offset:32768
  ds_read_b64_tr_b16 v[210:211], v246 offset:33024
  v_mfma_f32_16x16x32_bf16 v[224:227], v[232:235], v[192:195], v[224:227]
  v_lshlrev_b32 v14, 16, v103
  v_and_b32 v15, s82, v103
  v_add_f32 v8, v8, v14
  v_add_f32 v9, v9, v15
  v_fmac_f32 v10, v14, v14
  v_fmac_f32 v11, v15, v15
  s_waitcnt lgkmcnt(6)
  v_mfma_f32_32x32x16_bf16 v[176:191], v[196:199], v[64:67], v[176:191]
  ds_read_b64_tr_b16 v[212:213], v246 offset:40960
  ds_read_b64_tr_b16 v[214:215], v246 offset:41216
  v_mfma_f32_16x16x32_bf16 v[228:231], v[232:235], v[196:199], v[228:231]
  s_waitcnt lgkmcnt(6)
  v_mfma_f32_32x32x16_bf16 v[160:175], v[200:203], v[68:71], v[160:175]
  ds_read_b64_tr_b16 v[192:193], v247 offset:32768
  ds_read_b64_tr_b16 v[194:195], v247 offset:33024
  s_waitcnt lgkmcnt(6)
  v_mfma_f32_32x32x16_bf16 v[176:191], v[204:207], v[68:71], v[176:191]
  ds_read_b64_tr_b16 v[196:197], v247 offset:40960
  ds_read_b64_tr_b16 v[198:199], v247 offset:41216
  s_waitcnt lgkmcnt(6)
  v_mfma_f32_32x32x16_bf16 v[160:175], v[208:211], v[72:75], v[160:175]
  s_waitcnt vmcnt(7)
  s_barrier
  v_add_u32 v244, 65536, v244
  v_add_u32 v245, 65536, v245
  v_add_u32 v246, 65536, v246
  v_add_u32 v247, 65536, v247
  v_subrev_u32 v244, s90, v244
  v_subrev_u32 v245, s90, v245
  v_subrev_u32 v246, s90, v246
  v_subrev_u32 v247, s90, v247
  ds_read_b64_tr_b16 v[200:201], v244 offset:0
  ds_read_b64_tr_b16 v[202:203], v244 offset:256
  ds_read_b128 v[112:115], v248 offset:49152
  s_waitcnt lgkmcnt(7)
  v_mfma_f32_32x32x16_bf16 v[176:191], v[212:215], v[72:75], v[176:191]
  ds_read_b64_tr_b16 v[204:205], v244 offset:8192
  ds_read_b64_tr_b16 v[206:207], v244 offset:8448
  s_add_u32 m0, s68, 49152
  s_mul_i32 s23, s22, 172032
  s_add_u32 s23, s23, s73
  buffer_load_dwordx4 v6, s[56:59], s23 offen lds
  s_waitcnt lgkmcnt(7)
  v_mfma_f32_32x32x16_bf16 v[160:175], v[192:195], v[76:79], v[160:175]
  ds_read_b64_tr_b16 v[208:209], v245 offset:0
  ds_read_b64_tr_b16 v[210:211], v245 offset:256
  ds_read_b128 v[116:119], v249 offset:49152
  s_add_u32 m0, s68, 65536
  s_mul_i32 s23, s16, 172032
  s_add_u32 s23, s23, s73
  buffer_load_dwordx4 v6, s[56:59], s23 offen lds
  s_waitcnt lgkmcnt(8)
  v_mfma_f32_32x32x16_bf16 v[176:191], v[196:199], v[76:79], v[176:191]
  ds_read_b64_tr_b16 v[212:213], v245 offset:8192
  ds_read_b64_tr_b16 v[214:215], v245 offset:8448
  s_add_u32 m0, s68, 73728
  s_mul_i32 s24, s17, 172032
  s_add_u32 s24, s24, s73
  buffer_load_dwordx4 v6, s[56:59], s24 offen lds
  s_waitcnt lgkmcnt(7)
  v_mfma_f32_32x32x16_bf16 v[128:143], v[200:203], v[112:115], v[128:143]
  ds_read_b64_tr_b16 v[192:193], v246 offset:0
  ds_read_b64_tr_b16 v[194:195], v246 offset:256
  ds_read_b128 v[120:123], v250 offset:49152
  v_mfma_f32_16x16x32_bf16 v[216:219], v[232:235], v[200:203], v[216:219]
  s_add_u32 m0, s68, 81920
  s_mul_i32 s23, s18, 172032
  s_add_u32 s23, s23, s73
  buffer_load_dwordx4 v6, s[56:59], s23 offen lds
  v_lshlrev_b32 v12, 16, v112
  v_and_b32 v13, s82, v112
  v_add_f32 v8, v8, v12
  v_add_f32 v9, v9, v13
  v_fmac_f32 v10, v12, v12
  v_fmac_f32 v11, v13, v13
  s_waitcnt lgkmcnt(8)
  v_mfma_f32_32x32x16_bf16 v[144:159], v[204:207], v[112:115], v[144:159]
  ds_read_b64_tr_b16 v[196:197], v246 offset:8192
  ds_read_b64_tr_b16 v[198:199], v246 offset:8448
  v_mfma_f32_16x16x32_bf16 v[220:223], v[232:235], v[204:207], v[220:223]
  v_lshlrev_b32 v14, 16, v113
  v_and_b32 v15, s82, v113
  v_add_f32 v8, v8, v14
  v_add_f32 v9, v9, v15
  v_fmac_f32 v10, v14, v14
  v_fmac_f32 v11, v15, v15
  s_waitcnt lgkmcnt(7)
  v_mfma_f32_32x32x16_bf16 v[128:143], v[208:211], v[116:119], v[128:143]
  ds_read_b64_tr_b16 v[200:201], v247 offset:0
  ds_read_b64_tr_b16 v[202:203], v247 offset:256
  ds_read_b128 v[124:127], v251 offset:49152
  v_lshlrev_b32 v12, 16, v114
  v_and_b32 v13, s82, v114
  v_add_f32 v8, v8, v12
  v_add_f32 v9, v9, v13
  v_fmac_f32 v10, v12, v12
  v_fmac_f32 v11, v13, v13
  s_waitcnt lgkmcnt(8)
  v_mfma_f32_32x32x16_bf16 v[144:159], v[212:215], v[116:119], v[144:159]
  ds_read_b64_tr_b16 v[204:205], v247 offset:8192
  ds_read_b64_tr_b16 v[206:207], v247 offset:8448
  v_lshlrev_b32 v14, 16, v115
  v_and_b32 v15, s82, v115
  v_add_f32 v8, v8, v14
  v_add_f32 v9, v9, v15
  v_fmac_f32 v10, v14, v14
  v_fmac_f32 v11, v15, v15
  s_waitcnt lgkmcnt(7)
  v_mfma_f32_32x32x16_bf16 v[128:143], v[192:195], v[120:123], v[128:143]
  v_lshlrev_b32 v12, 16, v116
  v_and_b32 v13, s82, v116
  v_add_f32 v8, v8, v12
  v_add_f32 v9, v9, v13
  v_fmac_f32 v10, v12, v12
  v_fmac_f32 v11, v13, v13
  v_lshlrev_b32 v14, 16, v117
  v_and_b32 v15, s82, v117
  v_add_f32 v8, v8, v14
  v_add_f32 v9, v9, v15
  v_fmac_f32 v10, v14, v14
  v_fmac_f32 v11, v15, v15
  v_lshlrev_b32 v12, 16, v118
  v_and_b32 v13, s82, v118
  v_add_f32 v8, v8, v12
  v_add_f32 v9, v9, v13
  v_fmac_f32 v10, v12, v12
  v_fmac_f32 v11, v13, v13
  v_lshlrev_b32 v14, 16, v119
  v_and_b32 v15, s82, v119
  v_add_f32 v8, v8, v14
  v_add_f32 v9, v9, v15
  v_fmac_f32 v10, v14, v14
  v_fmac_f32 v11, v15, v15
  ds_write_b32 v255, v216 offset:4096
  ds_write_b32 v255, v220 offset:4608
  v_add_f32 v8, v8, v9
  v_add_f32 v9, v10, v11
  v_and_b32 v12, 31, v0
  v_lshlrev_b32 v12, 5, v12
  s_lshl_b32 s9, s4, 10
  s_add_u32 s9, s9, 155648
  v_add_u32 v2, s9, v12
  v_lshrrev_b32 v13, 5, v0
  v_lshl_add_u32 v12, v13, 3, v2
  s_lshl_b32 s9, s5, 4
  v_add_u32 v12, s9, v12
  ds_write_b64 v12, v[8:9]
  v_and_b32 v3, -16, v255
  s_waitcnt vmcnt(9) lgkmcnt(0)
  s_barrier
  ds_read_b128 v[8:11], v2
  ds_read_b128 v[12:15], v2 offset:16
  ds_read_b128 v[216:219], v3 offset:4096
  ds_read_b128 v[220:223], v3 offset:4608
  v_add_u32 v244, 4294836224, v244
  v_add_u32 v245, 4294836224, v245
  v_add_u32 v246, 4294836224, v246
  v_add_u32 v247, 4294836224, v247
  v_add_u32 v244, s90, v244
  v_add_u32 v245, s90, v245
  v_add_u32 v246, s90, v246
  v_add_u32 v247, s90, v247
  ds_read_b64_tr_b16 v[208:209], v244 offset:0
  ds_read_b64_tr_b16 v[210:211], v244 offset:256
  s_waitcnt lgkmcnt(14)
  v_mfma_f32_32x32x16_bf16 v[144:159], v[196:199], v[120:123], v[144:159]
  ds_read_b64_tr_b16 v[212:213], v244 offset:8192
  ds_read_b64_tr_b16 v[214:215], v244 offset:8448
  s_add_u32 m0, s68, 90112
  s_mul_i32 s24, s19, 172032
  s_add_u32 s24, s24, s73
  buffer_load_dwordx4 v6, s[56:59], s24 offen lds
  s_waitcnt lgkmcnt(4)
  v_add_f32 v8, v8, v10
  v_add_f32 v9, v9, v11
  v_add_f32 v12, v12, v14
  v_add_f32 v13, v13, v15
  v_add_f32 v8, v8, v12
  s_waitcnt lgkmcnt(13)
  v_mfma_f32_32x32x16_bf16 v[128:143], v[200:203], v[124:127], v[128:143]
  ds_read_b64_tr_b16 v[192:193], v245 offset:0
  ds_read_b64_tr_b16 v[194:195], v245 offset:256
  s_add_u32 m0, s68, 98304
  s_mul_i32 s23, s20, 172032
  s_add_u32 s23, s23, s73
  buffer_load_dwordx4 v6, s[56:59], s23 offen lds
  v_add_f32 v9, v9, v13
  v_mul_f32 v8, 0xbb124925, v8
  v_mul_f32 v9, 0x3b124925, v9
  v_fma_f32 v9, -v8, v8, v9
  v_max_f32 v9, 0, v9
  v_add_f32 v9, 0x3727c5ac, v9
  s_waitcnt lgkmcnt(13)
  v_mfma_f32_32x32x16_bf16 v[144:159], v[204:207], v[124:127], v[144:159]
  ds_read_b64_tr_b16 v[196:197], v245 offset:8192
  ds_read_b64_tr_b16 v[198:199], v245 offset:8448
  v_rsq_f32 v254, v9
  v_cvt_pk_bf16_f32 v236, v8, v8
  v_mul_f32 v253, v9, v254
  v_mul_f32 v252, 0xbfb8aa3b, v254
  v_lshlrev_b32 v10, 16, v236
  s_waitcnt lgkmcnt(6)
  v_mfma_f32_32x32x16_bf16 v[160:175], v[208:211], v[80:83], v[160:175]
  ds_read_b64_tr_b16 v[200:201], v246 offset:0
  ds_read_b64_tr_b16 v[202:203], v246 offset:256
  v_mfma_f32_16x16x32_bf16 v[224:227], v[232:235], v[208:211], v[224:227]
  v_sub_f32 v10, v8, v10
  v_and_b32 v11, 31, v0
  s_lshl_b32 s9, s4, 7
  s_add_u32 s9, s9, 161792
  v_lshlrev_b32 v11, 2, v11
  v_add_u32 v11, s9, v11
  s_mov_b64 exec, s[84:85]
  v_cvt_pk_bf16_f32 v236, v10, v10
  s_mov_b64 exec, -1
  s_waitcnt lgkmcnt(6)
  v_mfma_f32_32x32x16_bf16 v[176:191], v[212:215], v[80:83], v[176:191]
  ds_read_b64_tr_b16 v[204:205], v246 offset:8192
  ds_read_b64_tr_b16 v[206:207], v246 offset:8448
  v_mfma_f32_16x16x32_bf16 v[228:231], v[232:235], v[212:215], v[228:231]
  ds_write_b32 v11, v254
  v_add_f32 v216, v216, v217
  v_add_f32 v218, v218, v219
  v_add_f32 v216, v216, v218
  v_cvt_pk_bf16_f32 v217, v216, v216
  v_lshlrev_b32 v218, 16, v217
  s_waitcnt lgkmcnt(7)
  v_mfma_f32_32x32x16_bf16 v[160:175], v[192:195], v[84:87], v[160:175]
  ds_read_b64_tr_b16 v[208:209], v247 offset:0
  ds_read_b64_tr_b16 v[210:211], v247 offset:256
  v_sub_f32 v218, v216, v218
  v_cvt_pk_bf16_f32 v240, v216, v218
  s_nop 1
  v_mfma_f32_32x32x16_bf16 v[128:143], v[240:243], v[236:239], v[128:143]
  v_add_f32 v220, v220, v221
  v_add_f32 v222, v222, v223
  s_waitcnt lgkmcnt(7)
  v_mfma_f32_32x32x16_bf16 v[176:191], v[196:199], v[84:87], v[176:191]
  ds_read_b64_tr_b16 v[212:213], v247 offset:8192
  ds_read_b64_tr_b16 v[214:215], v247 offset:8448
  v_add_f32 v220, v220, v222
  v_cvt_pk_bf16_f32 v221, v220, v220
  v_lshlrev_b32 v222, 16, v221
  v_sub_f32 v222, v220, v222
  v_cvt_pk_bf16_f32 v240, v220, v222
  s_nop 1
  v_mfma_f32_32x32x16_bf16 v[144:159], v[240:243], v[236:239], v[144:159]
  s_waitcnt lgkmcnt(7)
  v_mfma_f32_32x32x16_bf16 v[160:175], v[200:203], v[88:91], v[160:175]
  s_waitcnt vmcnt(9)
  s_barrier
  ds_read_b64_tr_b16 v[192:193], v244 offset:16384
  ds_read_b64_tr_b16 v[194:195], v244 offset:16640
  v_mul_f32 v128, v252, v128
  v_mul_f32 v129, v252, v129
  v_mul_f32 v130, v252, v130
  v_mul_f32 v131, v252, v131
  v_exp_f32 v128, v128
  s_waitcnt lgkmcnt(7)
  v_mfma_f32_32x32x16_bf16 v[176:191], v[204:207], v[88:91], v[176:191]
  ds_read_b64_tr_b16 v[196:197], v244 offset:24576
  ds_read_b64_tr_b16 v[198:199], v244 offset:24832
  s_add_u32 m0, s68, 106496
  s_mul_i32 s24, s21, 172032
  s_add_u32 s24, s24, s73
  buffer_load_dwordx4 v6, s[56:59], s24 offen lds
  v_exp_f32 v129, v129
  v_exp_f32 v130, v130
  v_exp_f32 v131, v131
  s_waitcnt lgkmcnt(6)
  v_mfma_f32_32x32x16_bf16 v[160:175], v[208:211], v[92:95], v[160:175]
  ds_read_b64_tr_b16 v[200:201], v245 offset:16384
  ds_read_b64_tr_b16 v[202:203], v245 offset:16640
  v_fma_f32 v128, v128, v253, v253
  v_fma_f32 v129, v129, v253, v253
  v_fma_f32 v130, v130, v253, v253
  v_fma_f32 v131, v131, v253, v253
  v_rcp_f32 v128, v128
  s_waitcnt lgkmcnt(6)
  v_mfma_f32_32x32x16_bf16 v[176:191], v[212:215], v[92:95], v[176:191]
  ds_read_b64_tr_b16 v[204:205], v245 offset:24576
  ds_read_b64_tr_b16 v[206:207], v245 offset:24832
  v_rcp_f32 v129, v129
  v_rcp_f32 v130, v130
  v_rcp_f32 v131, v131
  s_waitcnt lgkmcnt(6)
  v_mfma_f32_32x32x16_bf16 v[160:175], v[192:195], v[96:99], v[160:175]
  ds_read_b64_tr_b16 v[208:209], v246 offset:16384
  ds_read_b64_tr_b16 v[210:211], v246 offset:16640
  v_mfma_f32_16x16x32_bf16 v[224:227], v[232:235], v[192:195], v[224:227]
  v_mul_f32 v128, v128, v144
  v_mul_f32 v129, v129, v145
  v_mul_f32 v130, v130, v146
  v_mul_f32 v131, v131, v147
  v_cvt_pk_bf16_f32 v144, v128, v129
  v_cvt_pk_bf16_f32 v145, v130, v131
  s_waitcnt lgkmcnt(6)
  v_mfma_f32_32x32x16_bf16 v[176:191], v[196:199], v[96:99], v[176:191]
  ds_read_b64_tr_b16 v[212:213], v246 offset:24576
  ds_read_b64_tr_b16 v[214:215], v246 offset:24832
  v_mfma_f32_16x16x32_bf16 v[228:231], v[232:235], v[196:199], v[228:231]
  v_mul_f32 v132, v252, v132
  v_mul_f32 v133, v252, v133
  v_mul_f32 v134, v252, v134
  v_mul_f32 v135, v252, v135
  v_exp_f32 v132, v132
  s_waitcnt lgkmcnt(6)
  v_mfma_f32_32x32x16_bf16 v[160:175], v[200:203], v[100:103], v[160:175]
  ds_read_b64_tr_b16 v[192:193], v247 offset:16384
  ds_read_b64_tr_b16 v[194:195], v247 offset:16640
  v_exp_f32 v133, v133
  v_exp_f32 v134, v134
  v_exp_f32 v135, v135
  s_waitcnt lgkmcnt(6)
  v_mfma_f32_32x32x16_bf16 v[176:191], v[204:207], v[100:103], v[176:191]
  ds_read_b64_tr_b16 v[196:197], v247 offset:24576
  ds_read_b64_tr_b16 v[198:199], v247 offset:24832
  v_fma_f32 v132, v132, v253, v253
  v_fma_f32 v133, v133, v253, v253
  v_fma_f32 v134, v134, v253, v253
  v_fma_f32 v135, v135, v253, v253
  v_rcp_f32 v132, v132
  s_waitcnt lgkmcnt(6)
  v_mfma_f32_32x32x16_bf16 v[160:175], v[208:211], v[104:107], v[160:175]
  s_waitcnt vmcnt(7)
  s_barrier
  ds_read_b64_tr_b16 v[200:201], v244 offset:32768
  ds_read_b64_tr_b16 v[202:203], v244 offset:33024
  v_rcp_f32 v133, v133
  v_rcp_f32 v134, v134
  v_rcp_f32 v135, v135
  s_waitcnt lgkmcnt(6)
  v_mfma_f32_32x32x16_bf16 v[176:191], v[212:215], v[104:107], v[176:191]
  ds_read_b64_tr_b16 v[204:205], v244 offset:40960
  ds_read_b64_tr_b16 v[206:207], v244 offset:41216
  v_mul_f32 v132, v132, v148
  v_mul_f32 v133, v133, v149
  v_mul_f32 v134, v134, v150
  v_mul_f32 v135, v135, v151
  v_cvt_pk_bf16_f32 v146, v132, v133
  v_cvt_pk_bf16_f32 v147, v134, v135
  s_waitcnt lgkmcnt(6)
  v_mfma_f32_32x32x16_bf16 v[160:175], v[192:195], v[108:111], v[160:175]
  ds_read_b64_tr_b16 v[208:209], v245 offset:32768
  ds_read_b64_tr_b16 v[210:211], v245 offset:33024
  buffer_store_dwordx4 v[144:147], v1, s[64:67], s75 offen offset:0 sc1
  v_mul_f32 v136, v252, v136
  v_mul_f32 v137, v252, v137
  v_mul_f32 v138, v252, v138
  v_mul_f32 v139, v252, v139
  s_waitcnt lgkmcnt(6)
  v_mfma_f32_32x32x16_bf16 v[176:191], v[196:199], v[108:111], v[176:191]
  ds_read_b64_tr_b16 v[212:213], v245 offset:40960
  ds_read_b64_tr_b16 v[214:215], v245 offset:41216
  v_exp_f32 v136, v136
  v_exp_f32 v137, v137
  v_exp_f32 v138, v138
  s_waitcnt lgkmcnt(6)
  v_mfma_f32_32x32x16_bf16 v[160:175], v[200:203], v[112:115], v[160:175]
  ds_read_b64_tr_b16 v[192:193], v246 offset:32768
  ds_read_b64_tr_b16 v[194:195], v246 offset:33024
  v_mfma_f32_16x16x32_bf16 v[224:227], v[232:235], v[200:203], v[224:227]
  v_exp_f32 v139, v139
  v_fma_f32 v136, v136, v253, v253
  v_fma_f32 v137, v137, v253, v253
  v_fma_f32 v138, v138, v253, v253
  v_fma_f32 v139, v139, v253, v253
  s_waitcnt lgkmcnt(6)
  v_mfma_f32_32x32x16_bf16 v[176:191], v[204:207], v[112:115], v[176:191]
  ds_read_b64_tr_b16 v[196:197], v246 offset:40960
  ds_read_b64_tr_b16 v[198:199], v246 offset:41216
  v_mfma_f32_16x16x32_bf16 v[228:231], v[232:235], v[204:207], v[228:231]
  v_rcp_f32 v136, v136
  v_rcp_f32 v137, v137
  v_rcp_f32 v138, v138
  s_waitcnt lgkmcnt(6)
  v_mfma_f32_32x32x16_bf16 v[160:175], v[208:211], v[116:119], v[160:175]
  ds_read_b64_tr_b16 v[200:201], v247 offset:32768
  ds_read_b64_tr_b16 v[202:203], v247 offset:33024
  v_rcp_f32 v139, v139
  v_mul_f32 v136, v136, v152
  v_mul_f32 v137, v137, v153
  v_mul_f32 v138, v138, v154
  v_mul_f32 v139, v139, v155
  s_waitcnt lgkmcnt(6)
  v_mfma_f32_32x32x16_bf16 v[176:191], v[212:215], v[116:119], v[176:191]
  ds_read_b64_tr_b16 v[204:205], v247 offset:40960
  ds_read_b64_tr_b16 v[206:207], v247 offset:41216
  v_cvt_pk_bf16_f32 v148, v136, v137
  v_cvt_pk_bf16_f32 v149, v138, v139
  v_mul_f32 v140, v252, v140
  v_mul_f32 v141, v252, v141
  v_mul_f32 v142, v252, v142
  v_mul_f32 v143, v252, v143
  s_waitcnt lgkmcnt(6)
  v_mfma_f32_32x32x16_bf16 v[160:175], v[192:195], v[120:123], v[160:175]
  ds_write_b32 v255, v224 offset:0
  ds_write_b32 v255, v228 offset:512
  s_waitcnt vmcnt(7) lgkmcnt(0)
  s_barrier
  ds_read_b128 v[224:227], v3
  ds_read_b128 v[228:231], v3 offset:512
  v_subrev_u32 v244, s90, v244
  v_subrev_u32 v245, s90, v245
  v_subrev_u32 v246, s90, v246
  v_subrev_u32 v247, s90, v247
  v_add_u32 v244, s91, v244
  v_add_u32 v245, s91, v245
  v_add_u32 v246, s91, v246
  v_add_u32 v247, s91, v247
  ds_read_b64_tr_b16 v[208:209], v244 offset:49152
  ds_read_b64_tr_b16 v[210:211], v244 offset:49408
  v_exp_f32 v140, v140
  v_exp_f32 v141, v141
  v_exp_f32 v142, v142
  s_waitcnt lgkmcnt(10)
  v_mfma_f32_32x32x16_bf16 v[176:191], v[196:199], v[120:123], v[176:191]
  ds_read_b64_tr_b16 v[212:213], v245 offset:49152
  ds_read_b64_tr_b16 v[214:215], v245 offset:49408
  v_exp_f32 v143, v143
  v_fma_f32 v140, v140, v253, v253
  v_fma_f32 v141, v141, v253, v253
  v_fma_f32 v142, v142, v253, v253
  v_fma_f32 v143, v143, v253, v253
  s_waitcnt lgkmcnt(10)
  v_mfma_f32_32x32x16_bf16 v[160:175], v[200:203], v[124:127], v[160:175]
  ds_read_b64_tr_b16 v[192:193], v246 offset:49152
  ds_read_b64_tr_b16 v[194:195], v246 offset:49408
  v_rcp_f32 v140, v140
  v_rcp_f32 v141, v141
  v_rcp_f32 v142, v142
  s_waitcnt lgkmcnt(10)
  v_mfma_f32_32x32x16_bf16 v[176:191], v[204:207], v[124:127], v[176:191]
  ds_read_b64_tr_b16 v[196:197], v247 offset:49152
  ds_read_b64_tr_b16 v[198:199], v247 offset:49408
  v_rcp_f32 v143, v143
  v_mul_f32 v140, v140, v156
  v_mul_f32 v141, v141, v157
  v_mul_f32 v142, v142, v158
  v_mul_f32 v143, v143, v159
  v_cvt_pk_bf16_f32 v150, v140, v141
  v_cvt_pk_bf16_f32 v151, v142, v143
  buffer_store_dwordx4 v[148:151], v1, s[64:67], s75 offen offset:1024 sc1
  s_cmp_lt_u32 s8, 2
  s_cbranch_scc1 L_k1_V
  s_cmp_eq_u32 s8, 3
  s_cbranch_scc1 L_k1_Q
  s_waitcnt lgkmcnt(6)
  v_mfma_f32_32x32x16_bf16 v[128:143], v[208:211], v[112:115], 0
  s_waitcnt vmcnt(6)
  s_barrier
  v_add_u32 v244, 65536, v244
  v_add_u32 v245, 65536, v245
  v_add_u32 v246, 65536, v246
  v_add_u32 v247, 65536, v247
  ds_read_b64_tr_b16 v[200:201], v244 offset:0
  ds_read_b64_tr_b16 v[202:203], v244 offset:256
  v_mfma_f32_16x16x32_bf16 v[216:219], v[232:235], v[208:211], 0
  s_waitcnt lgkmcnt(10)
  v_add_f32 v224, v224, v225
  v_add_f32 v226, v226, v227
  v_add_f32 v224, v224, v226
  v_cvt_pk_bf16_f32 v225, v224, v224
  v_lshlrev_b32 v226, 16, v225
  s_waitcnt lgkmcnt(6)
  v_mfma_f32_32x32x16_bf16 v[128:143], v[212:215], v[116:119], v[128:143]
  ds_read_b64_tr_b16 v[204:205], v244 offset:8192
  ds_read_b64_tr_b16 v[206:207], v244 offset:8448
  v_sub_f32 v226, v224, v226
  v_cvt_pk_bf16_f32 v240, v224, v226
  s_nop 1
  v_mfma_f32_32x32x16_bf16 v[160:175], v[240:243], v[236:239], v[160:175]
  v_add_f32 v228, v228, v229
  v_add_f32 v230, v230, v231
  s_waitcnt lgkmcnt(6)
  v_mfma_f32_32x32x16_bf16 v[128:143], v[192:195], v[120:123], v[128:143]
  ds_read_b64_tr_b16 v[208:209], v245 offset:0
  ds_read_b64_tr_b16 v[210:211], v245 offset:256
  v_add_f32 v228, v228, v230
  v_cvt_pk_bf16_f32 v229, v228, v228
  v_lshlrev_b32 v230, 16, v229
  v_sub_f32 v230, v228, v230
  v_cvt_pk_bf16_f32 v240, v228, v230
  s_nop 1
  v_mfma_f32_32x32x16_bf16 v[176:191], v[240:243], v[236:239], v[176:191]
  s_waitcnt lgkmcnt(6)
  v_mfma_f32_32x32x16_bf16 v[128:143], v[196:199], v[124:127], v[128:143]
  ds_read_b64_tr_b16 v[212:213], v245 offset:8192
  ds_read_b64_tr_b16 v[214:215], v245 offset:8448
  v_mul_f32 v160, v252, v160
  v_mul_f32 v161, v252, v161
  v_mul_f32 v162, v252, v162
  v_mul_f32 v163, v252, v163
  v_exp_f32 v160, v160
  s_waitcnt lgkmcnt(6)
  v_mfma_f32_32x32x16_bf16 v[128:143], v[200:203], v[16:19], v[128:143]
  ds_read_b64_tr_b16 v[192:193], v246 offset:0
  ds_read_b64_tr_b16 v[194:195], v246 offset:256
  v_mfma_f32_16x16x32_bf16 v[216:219], v[232:235], v[200:203], v[216:219]
  v_exp_f32 v161, v161
  v_exp_f32 v162, v162
  v_exp_f32 v163, v163
  s_waitcnt lgkmcnt(6)
  v_mfma_f32_32x32x16_bf16 v[128:143], v[204:207], v[32:35], v[128:143]
  ds_read_b64_tr_b16 v[196:197], v246 offset:8192
  ds_read_b64_tr_b16 v[198:199], v246 offset:8448
  v_mfma_f32_16x16x32_bf16 v[216:219], v[232:235], v[204:207], v[216:219]
  v_fma_f32 v160, v160, v253, v253
  v_fma_f32 v161, v161, v253, v253
  v_fma_f32 v162, v162, v253, v253
  v_fma_f32 v163, v163, v253, v253
  v_rcp_f32 v160, v160
  s_waitcnt lgkmcnt(6)
  v_mfma_f32_32x32x16_bf16 v[128:143], v[208:211], v[20:23], v[128:143]
  ds_read_b64_tr_b16 v[200:201], v247 offset:0
  ds_read_b64_tr_b16 v[202:203], v247 offset:256
  v_rcp_f32 v161, v161
  v_rcp_f32 v162, v162
  v_rcp_f32 v163, v163
  s_waitcnt lgkmcnt(6)
  v_mfma_f32_32x32x16_bf16 v[128:143], v[212:215], v[36:39], v[128:143]
  ds_read_b64_tr_b16 v[204:205], v247 offset:8192
  ds_read_b64_tr_b16 v[206:207], v247 offset:8448
  v_mul_f32 v160, v160, v176
  v_mul_f32 v161, v161, v177
  v_mul_f32 v162, v162, v178
  v_mul_f32 v163, v163, v179
  v_cvt_pk_bf16_f32 v176, v160, v161
  v_cvt_pk_bf16_f32 v177, v162, v163
  s_waitcnt lgkmcnt(6)
  v_mfma_f32_32x32x16_bf16 v[128:143], v[192:195], v[24:27], v[128:143]
  s_waitcnt vmcnt(4)
  s_barrier
  ds_read_b64_tr_b16 v[208:209], v244 offset:16384
  ds_read_b64_tr_b16 v[210:211], v244 offset:16640
  v_mul_f32 v164, v252, v164
  v_mul_f32 v165, v252, v165
  v_mul_f32 v166, v252, v166
  v_mul_f32 v167, v252, v167
  v_exp_f32 v164, v164
  s_waitcnt lgkmcnt(6)
  v_mfma_f32_32x32x16_bf16 v[128:143], v[196:199], v[40:43], v[128:143]
  ds_read_b64_tr_b16 v[212:213], v244 offset:24576
  ds_read_b64_tr_b16 v[214:215], v244 offset:24832
  v_exp_f32 v165, v165
  v_exp_f32 v166, v166
  v_exp_f32 v167, v167
  s_waitcnt lgkmcnt(6)
  v_mfma_f32_32x32x16_bf16 v[128:143], v[200:203], v[28:31], v[128:143]
  ds_read_b64_tr_b16 v[192:193], v245 offset:16384
  ds_read_b64_tr_b16 v[194:195], v245 offset:16640
  v_fma_f32 v164, v164, v253, v253
  v_fma_f32 v165, v165, v253, v253
  v_fma_f32 v166, v166, v253, v253
  v_fma_f32 v167, v167, v253, v253
  v_rcp_f32 v164, v164
  s_waitcnt lgkmcnt(6)
  v_mfma_f32_32x32x16_bf16 v[128:143], v[204:207], v[44:47], v[128:143]
  ds_read_b64_tr_b16 v[196:197], v245 offset:24576
  ds_read_b64_tr_b16 v[198:199], v245 offset:24832
  v_rcp_f32 v165, v165
  v_rcp_f32 v166, v166
  v_rcp_f32 v167, v167
  s_waitcnt lgkmcnt(6)
  v_mfma_f32_32x32x16_bf16 v[128:143], v[208:211], v[48:51], v[128:143]
  ds_read_b64_tr_b16 v[200:201], v246 offset:16384
  ds_read_b64_tr_b16 v[202:203], v246 offset:16640
  v_mfma_f32_16x16x32_bf16 v[216:219], v[232:235], v[208:211], v[216:219]
  v_mul_f32 v164, v164, v180
  v_mul_f32 v165, v165, v181
  v_mul_f32 v166, v166, v182
  v_mul_f32 v167, v167, v183
  v_cvt_pk_bf16_f32 v178, v164, v165
  v_cvt_pk_bf16_f32 v179, v166, v167
  s_waitcnt lgkmcnt(6)
  v_mfma_f32_32x32x16_bf16 v[128:143], v[212:215], v[64:67], v[128:143]
  ds_read_b64_tr_b16 v[204:205], v246 offset:24576
  ds_read_b64_tr_b16 v[206:207], v246 offset:24832
  v_mfma_f32_16x16x32_bf16 v[216:219], v[232:235], v[212:215], v[216:219]
  buffer_store_dwordx4 v[176:179], v1, s[64:67], s76 offen offset:0 sc1
  v_mul_f32 v168, v252, v168
  v_mul_f32 v169, v252, v169
  v_mul_f32 v170, v252, v170
  v_mul_f32 v171, v252, v171
  s_waitcnt lgkmcnt(6)
  v_mfma_f32_32x32x16_bf16 v[128:143], v[192:195], v[52:55], v[128:143]
  ds_read_b64_tr_b16 v[208:209], v247 offset:16384
  ds_read_b64_tr_b16 v[210:211], v247 offset:16640
  v_exp_f32 v168, v168
  v_exp_f32 v169, v169
  v_exp_f32 v170, v170
  s_waitcnt lgkmcnt(6)
  v_mfma_f32_32x32x16_bf16 v[128:143], v[196:199], v[68:71], v[128:143]
  ds_read_b64_tr_b16 v[212:213], v247 offset:24576
  ds_read_b64_tr_b16 v[214:215], v247 offset:24832
  v_exp_f32 v171, v171
  v_fma_f32 v168, v168, v253, v253
  v_fma_f32 v169, v169, v253, v253
  v_fma_f32 v170, v170, v253, v253
  v_fma_f32 v171, v171, v253, v253
  s_waitcnt lgkmcnt(6)
  v_mfma_f32_32x32x16_bf16 v[128:143], v[200:203], v[56:59], v[128:143]
  s_waitcnt vmcnt(3)
  s_barrier
  ds_read_b64_tr_b16 v[192:193], v244 offset:32768
  ds_read_b64_tr_b16 v[194:195], v244 offset:33024
  v_rcp_f32 v168, v168
  v_rcp_f32 v169, v169
  v_rcp_f32 v170, v170
  s_waitcnt lgkmcnt(6)
  v_mfma_f32_32x32x16_bf16 v[128:143], v[204:207], v[72:75], v[128:143]
  ds_read_b64_tr_b16 v[196:197], v244 offset:40960
  ds_read_b64_tr_b16 v[198:199], v244 offset:41216
  v_rcp_f32 v171, v171
  v_mul_f32 v168, v168, v184
  v_mul_f32 v169, v169, v185
  v_mul_f32 v170, v170, v186
  v_mul_f32 v171, v171, v187
  s_waitcnt lgkmcnt(6)
  v_mfma_f32_32x32x16_bf16 v[128:143], v[208:211], v[60:63], v[128:143]
  ds_read_b64_tr_b16 v[200:201], v245 offset:32768
  ds_read_b64_tr_b16 v[202:203], v245 offset:33024
  v_cvt_pk_bf16_f32 v180, v168, v169
  v_cvt_pk_bf16_f32 v181, v170, v171
  v_mul_f32 v172, v252, v172
  v_mul_f32 v173, v252, v173
  v_mul_f32 v174, v252, v174
  v_mul_f32 v175, v252, v175
  s_waitcnt lgkmcnt(6)
  v_mfma_f32_32x32x16_bf16 v[128:143], v[212:215], v[76:79], v[128:143]
  ds_read_b64_tr_b16 v[204:205], v245 offset:40960
  ds_read_b64_tr_b16 v[206:207], v245 offset:41216
  v_exp_f32 v172, v172
  v_exp_f32 v173, v173
  v_exp_f32 v174, v174
  s_waitcnt lgkmcnt(6)
  v_mfma_f32_32x32x16_bf16 v[128:143], v[192:195], v[80:83], v[128:143]
  ds_read_b64_tr_b16 v[208:209], v246 offset:32768
  ds_read_b64_tr_b16 v[210:211], v246 offset:33024
  v_mfma_f32_16x16x32_bf16 v[216:219], v[232:235], v[192:195], v[216:219]
  v_exp_f32 v175, v175
  v_fma_f32 v172, v172, v253, v253
  v_fma_f32 v173, v173, v253, v253
  v_fma_f32 v174, v174, v253, v253
  v_fma_f32 v175, v175, v253, v253
  s_waitcnt lgkmcnt(6)
  v_mfma_f32_32x32x16_bf16 v[128:143], v[196:199], v[96:99], v[128:143]
  ds_read_b64_tr_b16 v[212:213], v246 offset:40960
  ds_read_b64_tr_b16 v[214:215], v246 offset:41216
  v_mfma_f32_16x16x32_bf16 v[216:219], v[232:235], v[196:199], v[216:219]
  v_rcp_f32 v172, v172
  v_rcp_f32 v173, v173
  v_rcp_f32 v174, v174
  s_waitcnt lgkmcnt(6)
  v_mfma_f32_32x32x16_bf16 v[128:143], v[200:203], v[84:87], v[128:143]
  ds_read_b64_tr_b16 v[192:193], v247 offset:32768
  ds_read_b64_tr_b16 v[194:195], v247 offset:33024
  v_rcp_f32 v175, v175
  v_mul_f32 v172, v172, v188
  v_mul_f32 v173, v173, v189
  v_mul_f32 v174, v174, v190
  v_mul_f32 v175, v175, v191
  s_waitcnt lgkmcnt(6)
  v_mfma_f32_32x32x16_bf16 v[128:143], v[204:207], v[100:103], v[128:143]
  ds_read_b64_tr_b16 v[196:197], v247 offset:40960
  ds_read_b64_tr_b16 v[198:199], v247 offset:41216
  v_cvt_pk_bf16_f32 v182, v172, v173
  v_cvt_pk_bf16_f32 v183, v174, v175
  buffer_store_dwordx4 v[180:183], v1, s[64:67], s76 offen offset:1024 sc1
  s_waitcnt lgkmcnt(6)
  v_mfma_f32_32x32x16_bf16 v[128:143], v[208:211], v[88:91], v[128:143]
  ds_write_b32 v255, v216 offset:4096
  s_waitcnt lgkmcnt(0)
  s_barrier
  ds_read_b128 v[220:223], v3 offset:4096
  s_waitcnt lgkmcnt(6)
  v_mfma_f32_32x32x16_bf16 v[128:143], v[212:215], v[104:107], v[128:143]
  s_waitcnt lgkmcnt(4)
  v_mfma_f32_32x32x16_bf16 v[128:143], v[192:195], v[92:95], v[128:143]
  s_waitcnt lgkmcnt(2)
  v_mfma_f32_32x32x16_bf16 v[128:143], v[196:199], v[108:111], v[128:143]
  s_waitcnt lgkmcnt(0)
  v_add_f32 v220, v220, v221
  v_add_f32 v222, v222, v223
  v_add_f32 v220, v220, v222
  v_cvt_pk_bf16_f32 v221, v220, v220
  v_lshlrev_b32 v222, 16, v221
  v_sub_f32 v222, v220, v222
  v_cvt_pk_bf16_f32 v240, v220, v222
  s_nop 1
  v_mfma_f32_32x32x16_bf16 v[128:143], v[240:243], v[236:239], v[128:143]
  s_nop 11
  v_mul_f32 v128, v254, v128
  v_mul_f32 v129, v254, v129
  v_cvt_pk_bf16_f32 v128, v128, v129
  v_mul_f32 v130, v254, v130
  v_mul_f32 v131, v254, v131
  v_cvt_pk_bf16_f32 v129, v130, v131
  v_mul_f32 v132, v254, v132
  v_mul_f32 v133, v254, v133
  v_cvt_pk_bf16_f32 v130, v132, v133
  v_mul_f32 v134, v254, v134
  v_mul_f32 v135, v254, v135
  v_cvt_pk_bf16_f32 v131, v134, v135
  buffer_store_dwordx4 v[128:131], v1, s[64:67], s78 offen sc1
  v_mul_f32 v136, v254, v136
  v_mul_f32 v137, v254, v137
  v_cvt_pk_bf16_f32 v132, v136, v137
  v_mul_f32 v138, v254, v138
  v_mul_f32 v139, v254, v139
  v_cvt_pk_bf16_f32 v133, v138, v139
  v_mul_f32 v140, v254, v140
  v_mul_f32 v141, v254, v141
  v_cvt_pk_bf16_f32 v134, v140, v141
  v_mul_f32 v142, v254, v142
  v_mul_f32 v143, v254, v143
  v_cvt_pk_bf16_f32 v135, v142, v143
  s_mov_b64 exec, s[84:85]
  v_mov_b32 v134, 0x3f803f80
  v_mov_b32 v135, 0x00003f80
  s_mov_b64 exec, -1
  buffer_store_dwordx4 v[132:135], v1, s[64:67], s78 offen offset:1024 sc1
  s_endpgm
L_k1_Q:
  s_waitcnt lgkmcnt(6)
  v_mfma_f32_32x32x16_bf16 v[128:143], v[208:211], v[112:115], 0
  s_waitcnt vmcnt(6)
  s_barrier
  v_add_u32 v244, 65536, v244
  v_add_u32 v245, 65536, v245
  v_add_u32 v246, 65536, v246
  v_add_u32 v247, 65536, v247
  ds_read_b64_tr_b16 v[200:201], v244 offset:0
  ds_read_b64_tr_b16 v[202:203], v244 offset:256
  v_mfma_f32_16x16x32_bf16 v[216:219], v[232:235], v[208:211], 0
  s_waitcnt lgkmcnt(10)
  v_add_f32 v224, v224, v225
  v_add_f32 v226, v226, v227
  v_add_f32 v224, v224, v226
  v_cvt_pk_bf16_f32 v225, v224, v224
  v_lshlrev_b32 v226, 16, v225
  s_waitcnt lgkmcnt(6)
  v_mfma_f32_32x32x16_bf16 v[128:143], v[212:215], v[116:119], v[128:143]
  ds_read_b64_tr_b16 v[204:205], v244 offset:8192
  ds_read_b64_tr_b16 v[206:207], v244 offset:8448
  v_sub_f32 v226, v224, v226
  v_cvt_pk_bf16_f32 v240, v224, v226
  s_nop 1
  v_mfma_f32_32x32x16_bf16 v[160:175], v[240:243], v[236:239], v[160:175]
  v_add_f32 v228, v228, v229
  v_add_f32 v230, v230, v231
  s_waitcnt lgkmcnt(6)
  v_mfma_f32_32x32x16_bf16 v[128:143], v[192:195], v[120:123], v[128:143]
  ds_read_b64_tr_b16 v[208:209], v245 offset:0
  ds_read_b64_tr_b16 v[210:211], v245 offset:256
  v_add_f32 v228, v228, v230
  v_cvt_pk_bf16_f32 v229, v228, v228
  v_lshlrev_b32 v230, 16, v229
  v_sub_f32 v230, v228, v230
  v_cvt_pk_bf16_f32 v240, v228, v230
  s_nop 1
  v_mfma_f32_32x32x16_bf16 v[176:191], v[240:243], v[236:239], v[176:191]
  s_waitcnt lgkmcnt(6)
  v_mfma_f32_32x32x16_bf16 v[128:143], v[196:199], v[124:127], v[128:143]
  ds_read_b64_tr_b16 v[212:213], v245 offset:8192
  ds_read_b64_tr_b16 v[214:215], v245 offset:8448
  v_mul_f32 v8, s83, v254
  v_mul_f32 v160, v8, v160
  v_mul_f32 v161, v8, v161
  v_cvt_pk_bf16_f32 v160, v160, v161
  v_mul_f32 v162, v8, v162
  v_mul_f32 v163, v8, v163
  s_waitcnt lgkmcnt(6)
  v_mfma_f32_32x32x16_bf16 v[128:143], v[200:203], v[16:19], v[128:143]
  ds_read_b64_tr_b16 v[192:193], v246 offset:0
  ds_read_b64_tr_b16 v[194:195], v246 offset:256
  v_mfma_f32_16x16x32_bf16 v[216:219], v[232:235], v[200:203], v[216:219]
  v_cvt_pk_bf16_f32 v161, v162, v163
  v_mul_f32 v164, v8, v164
  v_mul_f32 v165, v8, v165
  v_cvt_pk_bf16_f32 v162, v164, v165
  v_mul_f32 v166, v8, v166
  v_mul_f32 v167, v8, v167
  s_waitcnt lgkmcnt(6)
  v_mfma_f32_32x32x16_bf16 v[128:143], v[204:207], v[32:35], v[128:143]
  ds_read_b64_tr_b16 v[196:197], v246 offset:8192
  ds_read_b64_tr_b16 v[198:199], v246 offset:8448
  v_mfma_f32_16x16x32_bf16 v[216:219], v[232:235], v[204:207], v[216:219]
  v_cvt_pk_bf16_f32 v163, v166, v167
  buffer_store_dwordx4 v[160:163], v1, s[64:67], s76 offen sc1
  v_mul_f32 v168, v8, v168
  v_mul_f32 v169, v8, v169
  v_cvt_pk_bf16_f32 v164, v168, v169
  s_waitcnt lgkmcnt(6)
  v_mfma_f32_32x32x16_bf16 v[128:143], v[208:211], v[20:23], v[128:143]
  ds_read_b64_tr_b16 v[200:201], v247 offset:0
  ds_read_b64_tr_b16 v[202:203], v247 offset:256
  v_mul_f32 v170, v8, v170
  v_mul_f32 v171, v8, v171
  v_cvt_pk_bf16_f32 v165, v170, v171
  v_mul_f32 v172, v8, v172
  v_mul_f32 v173, v8, v173
  v_cvt_pk_bf16_f32 v166, v172, v173
  s_waitcnt lgkmcnt(6)
  v_mfma_f32_32x32x16_bf16 v[128:143], v[212:215], v[36:39], v[128:143]
  ds_read_b64_tr_b16 v[204:205], v247 offset:8192
  ds_read_b64_tr_b16 v[206:207], v247 offset:8448
  v_mul_f32 v174, v8, v174
  v_mul_f32 v175, v8, v175
  v_cvt_pk_bf16_f32 v167, v174, v175
  s_mov_b64 exec, s[84:85]
  v_mov_b32 v166, 0
  v_mov_b32 v167, 0
  s_mov_b64 exec, -1
  buffer_store_dwordx4 v[164:167], v1, s[64:67], s76 offen offset:1024 sc1
  s_waitcnt lgkmcnt(6)
  v_mfma_f32_32x32x16_bf16 v[128:143], v[192:195], v[24:27], v[128:143]
  s_waitcnt vmcnt(6)
  s_barrier
  ds_read_b64_tr_b16 v[208:209], v244 offset:16384
  ds_read_b64_tr_b16 v[210:211], v244 offset:16640
  v_mul_f32 v176, v8, v176
  v_mul_f32 v177, v8, v177
  v_cvt_pk_bf16_f32 v176, v176, v177
  v_mul_f32 v178, v8, v178
  v_mul_f32 v179, v8, v179
  v_cvt_pk_bf16_f32 v177, v178, v179
  s_waitcnt lgkmcnt(6)
  v_mfma_f32_32x32x16_bf16 v[128:143], v[196:199], v[40:43], v[128:143]
  ds_read_b64_tr_b16 v[212:213], v244 offset:24576
  ds_read_b64_tr_b16 v[214:215], v244 offset:24832
  v_mul_f32 v180, v8, v180
  v_mul_f32 v181, v8, v181
  v_cvt_pk_bf16_f32 v178, v180, v181
  v_mul_f32 v182, v8, v182
  v_mul_f32 v183, v8, v183
  v_cvt_pk_bf16_f32 v179, v182, v183
  s_waitcnt lgkmcnt(6)
  v_mfma_f32_32x32x16_bf16 v[128:143], v[200:203], v[28:31], v[128:143]
  ds_read_b64_tr_b16 v[192:193], v245 offset:16384
  ds_read_b64_tr_b16 v[194:195], v245 offset:16640
  buffer_store_dwordx4 v[176:179], v1, s[64:67], s77 offen sc1
  v_mul_f32 v184, v8, v184
  v_mul_f32 v185, v8, v185
  v_cvt_pk_bf16_f32 v180, v184, v185
  v_mul_f32 v186, v8, v186
  s_waitcnt lgkmcnt(6)
  v_mfma_f32_32x32x16_bf16 v[128:143], v[204:207], v[44:47], v[128:143]
  ds_read_b64_tr_b16 v[196:197], v245 offset:24576
  ds_read_b64_tr_b16 v[198:199], v245 offset:24832
  v_mul_f32 v187, v8, v187
  v_cvt_pk_bf16_f32 v181, v186, v187
  v_mul_f32 v188, v8, v188
  v_mul_f32 v189, v8, v189
  v_cvt_pk_bf16_f32 v182, v188, v189
  v_mul_f32 v190, v8, v190
  s_waitcnt lgkmcnt(6)
  v_mfma_f32_32x32x16_bf16 v[128:143], v[208:211], v[48:51], v[128:143]
  ds_read_b64_tr_b16 v[200:201], v246 offset:16384
  ds_read_b64_tr_b16 v[202:203], v246 offset:16640
  v_mfma_f32_16x16x32_bf16 v[216:219], v[232:235], v[208:211], v[216:219]
  v_mul_f32 v191, v8, v191
  v_cvt_pk_bf16_f32 v183, v190, v191
  s_mov_b64 exec, s[84:85]
  v_mov_b32 v182, 0
  v_mov_b32 v183, 0
  s_mov_b64 exec, -1
  buffer_store_dwordx4 v[180:183], v1, s[64:67], s77 offen offset:1024 sc1
  s_waitcnt lgkmcnt(6)
  v_mfma_f32_32x32x16_bf16 v[128:143], v[212:215], v[64:67], v[128:143]
  ds_read_b64_tr_b16 v[204:205], v246 offset:24576
  ds_read_b64_tr_b16 v[206:207], v246 offset:24832
  v_mfma_f32_16x16x32_bf16 v[216:219], v[232:235], v[212:215], v[216:219]
  s_waitcnt lgkmcnt(6)
  v_mfma_f32_32x32x16_bf16 v[128:143], v[192:195], v[52:55], v[128:143]
  ds_read_b64_tr_b16 v[208:209], v247 offset:16384
  ds_read_b64_tr_b16 v[210:211], v247 offset:16640
  s_waitcnt lgkmcnt(6)
  v_mfma_f32_32x32x16_bf16 v[128:143], v[196:199], v[68:71], v[128:143]
  ds_read_b64_tr_b16 v[212:213], v247 offset:24576
  ds_read_b64_tr_b16 v[214:215], v247 offset:24832
  s_waitcnt lgkmcnt(6)
  v_mfma_f32_32x32x16_bf16 v[128:143], v[200:203], v[56:59], v[128:143]
  s_waitcnt vmcnt(6)
  s_barrier
  ds_read_b64_tr_b16 v[192:193], v244 offset:32768
  ds_read_b64_tr_b16 v[194:195], v244 offset:33024
  s_waitcnt lgkmcnt(6)
  v_mfma_f32_32x32x16_bf16 v[128:143], v[204:207], v[72:75], v[128:143]
  ds_read_b64_tr_b16 v[196:197], v244 offset:40960
  ds_read_b64_tr_b16 v[198:199], v244 offset:41216
  s_waitcnt lgkmcnt(6)
  v_mfma_f32_32x32x16_bf16 v[128:143], v[208:211], v[60:63], v[128:143]
  ds_read_b64_tr_b16 v[200:201], v245 offset:32768
  ds_read_b64_tr_b16 v[202:203], v245 offset:33024
  s_waitcnt lgkmcnt(6)
  v_mfma_f32_32x32x16_bf16 v[128:143], v[212:215], v[76:79], v[128:143]
  ds_read_b64_tr_b16 v[204:205], v245 offset:40960
  ds_read_b64_tr_b16 v[206:207], v245 offset:41216
  s_waitcnt lgkmcnt(6)
  v_mfma_f32_32x32x16_bf16 v[128:143], v[192:195], v[80:83], v[128:143]
  ds_read_b64_tr_b16 v[208:209], v246 offset:32768
  ds_read_b64_tr_b16 v[210:211], v246 offset:33024
  v_mfma_f32_16x16x32_bf16 v[216:219], v[232:235], v[192:195], v[216:219]
  s_waitcnt lgkmcnt(6)
  v_mfma_f32_32x32x16_bf16 v[128:143], v[196:199], v[96:99], v[128:143]
  ds_read_b64_tr_b16 v[212:213], v246 offset:40960
  ds_read_b64_tr_b16 v[214:215], v246 offset:41216
  v_mfma_f32_16x16x32_bf16 v[216:219], v[232:235], v[196:199], v[216:219]
  s_waitcnt lgkmcnt(6)
  v_mfma_f32_32x32x16_bf16 v[128:143], v[200:203], v[84:87], v[128:143]
  ds_read_b64_tr_b16 v[192:193], v247 offset:32768
  ds_read_b64_tr_b16 v[194:195], v247 offset:33024
  s_waitcnt lgkmcnt(6)
  v_mfma_f32_32x32x16_bf16 v[128:143], v[204:207], v[100:103], v[128:143]
  ds_read_b64_tr_b16 v[196:197], v247 offset:40960
  ds_read_b64_tr_b16 v[198:199], v247 offset:41216
  s_waitcnt lgkmcnt(6)
  v_mfma_f32_32x32x16_bf16 v[128:143], v[208:211], v[88:91], v[128:143]
  ds_write_b32 v255, v216 offset:4096
  s_waitcnt lgkmcnt(0)
  s_barrier
  ds_read_b128 v[220:223], v3 offset:4096
  s_waitcnt lgkmcnt(6)
  v_mfma_f32_32x32x16_bf16 v[128:143], v[212:215], v[104:107], v[128:143]
  s_waitcnt lgkmcnt(4)
  v_mfma_f32_32x32x16_bf16 v[128:143], v[192:195], v[92:95], v[128:143]
  s_waitcnt lgkmcnt(2)
  v_mfma_f32_32x32x16_bf16 v[128:143], v[196:199], v[108:111], v[128:143]
  s_waitcnt lgkmcnt(0)
  v_add_f32 v220, v220, v221
  v_add_f32 v222, v222, v223
  v_add_f32 v220, v220, v222
  v_cvt_pk_bf16_f32 v221, v220, v220
  v_lshlrev_b32 v222, 16, v221
  v_sub_f32 v222, v220, v222
  v_cvt_pk_bf16_f32 v240, v220, v222
  s_nop 1
  v_mfma_f32_32x32x16_bf16 v[128:143], v[240:243], v[236:239], v[128:143]
  s_nop 11
  v_mul_f32 v128, v254, v128
  v_mul_f32 v129, v254, v129
  v_cvt_pk_bf16_f32 v128, v128, v129
  v_mul_f32 v130, v254, v130
  v_mul_f32 v131, v254, v131
  v_cvt_pk_bf16_f32 v129, v130, v131
  v_mul_f32 v132, v254, v132
  v_mul_f32 v133, v254, v133
  v_cvt_pk_bf16_f32 v130, v132, v133
  v_mul_f32 v134, v254, v134
  v_mul_f32 v135, v254, v135
  v_cvt_pk_bf16_f32 v131, v134, v135
  buffer_store_dwordx4 v[128:131], v1, s[64:67], s78 offen sc1
  v_mul_f32 v136, v254, v136
  v_mul_f32 v137, v254, v137
  v_cvt_pk_bf16_f32 v132, v136, v137
  v_mul_f32 v138, v254, v138
  v_mul_f32 v139, v254, v139
  v_cvt_pk_bf16_f32 v133, v138, v139
  v_mul_f32 v140, v254, v140
  v_mul_f32 v141, v254, v141
  v_cvt_pk_bf16_f32 v134, v140, v141
  v_mul_f32 v142, v254, v142
  v_mul_f32 v143, v254, v143
  v_cvt_pk_bf16_f32 v135, v142, v143
  s_mov_b64 exec, s[84:85]
  v_mov_b32 v134, 0x3f803f80
  v_mov_b32 v135, 0x00003f80
  s_mov_b64 exec, -1
  buffer_store_dwordx4 v[132:135], v1, s[64:67], s78 offen offset:1024 sc1
  s_endpgm
L_k1_V:
  s_waitcnt lgkmcnt(6)
  v_mfma_f32_32x32x16_bf16 v[128:143], v[112:115], v[208:211], 0
  s_waitcnt vmcnt(6)
  s_barrier
  v_add_u32 v244, 65536, v244
  v_add_u32 v245, 65536, v245
  v_add_u32 v246, 65536, v246
  v_add_u32 v247, 65536, v247
  ds_read_b64_tr_b16 v[200:201], v244 offset:0
  ds_read_b64_tr_b16 v[202:203], v244 offset:256
  v_mfma_f32_16x16x32_bf16 v[216:219], v[232:235], v[208:211], 0
  s_waitcnt lgkmcnt(10)
  v_add_f32 v224, v224, v225
  v_add_f32 v226, v226, v227
  v_add_f32 v224, v224, v226
  v_cvt_pk_bf16_f32 v225, v224, v224
  v_lshlrev_b32 v226, 16, v225
  s_waitcnt lgkmcnt(6)
  v_mfma_f32_32x32x16_bf16 v[128:143], v[116:119], v[212:215], v[128:143]
  ds_read_b64_tr_b16 v[204:205], v244 offset:8192
  ds_read_b64_tr_b16 v[206:207], v244 offset:8448
  v_sub_f32 v226, v224, v226
  v_cvt_pk_bf16_f32 v240, v224, v226
  s_nop 1
  v_mfma_f32_32x32x16_bf16 v[160:175], v[240:243], v[236:239], v[160:175]
  v_add_f32 v228, v228, v229
  v_add_f32 v230, v230, v231
  s_waitcnt lgkmcnt(6)
  v_mfma_f32_32x32x16_bf16 v[128:143], v[120:123], v[192:195], v[128:143]
  ds_read_b64_tr_b16 v[208:209], v245 offset:0
  ds_read_b64_tr_b16 v[210:211], v245 offset:256
  v_add_f32 v228, v228, v230
  v_cvt_pk_bf16_f32 v229, v228, v228
  v_lshlrev_b32 v230, 16, v229
  v_sub_f32 v230, v228, v230
  v_cvt_pk_bf16_f32 v240, v228, v230
  s_nop 1
  v_mfma_f32_32x32x16_bf16 v[176:191], v[240:243], v[236:239], v[176:191]
  s_waitcnt lgkmcnt(6)
  v_mfma_f32_32x32x16_bf16 v[128:143], v[124:127], v[196:199], v[128:143]
  ds_read_b64_tr_b16 v[212:213], v245 offset:8192
  ds_read_b64_tr_b16 v[214:215], v245 offset:8448
  v_mul_f32 v160, v252, v160
  v_mul_f32 v161, v252, v161
  v_mul_f32 v162, v252, v162
  v_mul_f32 v163, v252, v163
  v_exp_f32 v160, v160
  s_waitcnt lgkmcnt(6)
  v_mfma_f32_32x32x16_bf16 v[128:143], v[16:19], v[200:203], v[128:143]
  ds_read_b64_tr_b16 v[192:193], v246 offset:0
  ds_read_b64_tr_b16 v[194:195], v246 offset:256
  v_mfma_f32_16x16x32_bf16 v[216:219], v[232:235], v[200:203], v[216:219]
  v_exp_f32 v161, v161
  v_exp_f32 v162, v162
  v_exp_f32 v163, v163
  s_waitcnt lgkmcnt(6)
  v_mfma_f32_32x32x16_bf16 v[128:143], v[32:35], v[204:207], v[128:143]
  ds_read_b64_tr_b16 v[196:197], v246 offset:8192
  ds_read_b64_tr_b16 v[198:199], v246 offset:8448
  v_mfma_f32_16x16x32_bf16 v[216:219], v[232:235], v[204:207], v[216:219]
  v_fma_f32 v160, v160, v253, v253
  v_fma_f32 v161, v161, v253, v253
  v_fma_f32 v162, v162, v253, v253
  v_fma_f32 v163, v163, v253, v253
  v_rcp_f32 v160, v160
  s_waitcnt lgkmcnt(6)
  v_mfma_f32_32x32x16_bf16 v[128:143], v[20:23], v[208:211], v[128:143]
  ds_read_b64_tr_b16 v[200:201], v247 offset:0
  ds_read_b64_tr_b16 v[202:203], v247 offset:256
  v_rcp_f32 v161, v161
  v_rcp_f32 v162, v162
  v_rcp_f32 v163, v163
  s_waitcnt lgkmcnt(6)
  v_mfma_f32_32x32x16_bf16 v[128:143], v[36:39], v[212:215], v[128:143]
  ds_read_b64_tr_b16 v[204:205], v247 offset:8192
  ds_read_b64_tr_b16 v[206:207], v247 offset:8448
  v_mul_f32 v160, v160, v176
  v_mul_f32 v161, v161, v177
  v_mul_f32 v162, v162, v178
  v_mul_f32 v163, v163, v179
  v_cvt_pk_bf16_f32 v176, v160, v161
  v_cvt_pk_bf16_f32 v177, v162, v163
  s_waitcnt lgkmcnt(6)
  v_mfma_f32_32x32x16_bf16 v[128:143], v[24:27], v[192:195], v[128:143]
  s_waitcnt vmcnt(4)
  s_barrier
  ds_read_b64_tr_b16 v[208:209], v244 offset:16384
  ds_read_b64_tr_b16 v[210:211], v244 offset:16640
  v_mul_f32 v164, v252, v164
  v_mul_f32 v165, v252, v165
  v_mul_f32 v166, v252, v166
  v_mul_f32 v167, v252, v167
  v_exp_f32 v164, v164
  s_waitcnt lgkmcnt(6)
  v_mfma_f32_32x32x16_bf16 v[128:143], v[40:43], v[196:199], v[128:143]
  ds_read_b64_tr_b16 v[212:213], v244 offset:24576
  ds_read_b64_tr_b16 v[214:215], v244 offset:24832
  v_exp_f32 v165, v165
  v_exp_f32 v166, v166
  v_exp_f32 v167, v167
  s_waitcnt lgkmcnt(6)
  v_mfma_f32_32x32x16_bf16 v[128:143], v[28:31], v[200:203], v[128:143]
  ds_read_b64_tr_b16 v[192:193], v245 offset:16384
  ds_read_b64_tr_b16 v[194:195], v245 offset:16640
  v_fma_f32 v164, v164, v253, v253
  v_fma_f32 v165, v165, v253, v253
  v_fma_f32 v166, v166, v253, v253
  v_fma_f32 v167, v167, v253, v253
  v_rcp_f32 v164, v164
  s_waitcnt lgkmcnt(6)
  v_mfma_f32_32x32x16_bf16 v[128:143], v[44:47], v[204:207], v[128:143]
  ds_read_b64_tr_b16 v[196:197], v245 offset:24576
  ds_read_b64_tr_b16 v[198:199], v245 offset:24832
  v_rcp_f32 v165, v165
  v_rcp_f32 v166, v166
  v_rcp_f32 v167, v167
  s_waitcnt lgkmcnt(6)
  v_mfma_f32_32x32x16_bf16 v[128:143], v[48:51], v[208:211], v[128:143]
  ds_read_b64_tr_b16 v[200:201], v246 offset:16384
  ds_read_b64_tr_b16 v[202:203], v246 offset:16640
  v_mfma_f32_16x16x32_bf16 v[216:219], v[232:235], v[208:211], v[216:219]
  v_mul_f32 v164, v164, v180
  v_mul_f32 v165, v165, v181
  v_mul_f32 v166, v166, v182
  v_mul_f32 v167, v167, v183
  v_cvt_pk_bf16_f32 v178, v164, v165
  v_cvt_pk_bf16_f32 v179, v166, v167
  s_waitcnt lgkmcnt(6)
  v_mfma_f32_32x32x16_bf16 v[128:143], v[64:67], v[212:215], v[128:143]
  ds_read_b64_tr_b16 v[204:205], v246 offset:24576
  ds_read_b64_tr_b16 v[206:207], v246 offset:24832
  v_mfma_f32_16x16x32_bf16 v[216:219], v[232:235], v[212:215], v[216:219]
  buffer_store_dwordx4 v[176:179], v1, s[64:67], s76 offen offset:0 sc1
  v_mul_f32 v168, v252, v168
  v_mul_f32 v169, v252, v169
  v_mul_f32 v170, v252, v170
  v_mul_f32 v171, v252, v171
  s_waitcnt lgkmcnt(6)
  v_mfma_f32_32x32x16_bf16 v[128:143], v[52:55], v[192:195], v[128:143]
  v_lshrrev_b32 v9, 5, v0
  v_lshlrev_b32 v9, 4, v9
  s_lshl_b32 s9, s4, 7
  s_add_u32 s9, s9, 161792
  v_add_u32 v9, s9, v9
  ds_read_b128 v[112:115], v9 offset:0
  ds_read_b128 v[116:119], v9 offset:32
  ds_read_b128 v[120:123], v9 offset:64
  ds_read_b128 v[124:127], v9 offset:96
  ds_read_b64_tr_b16 v[208:209], v247 offset:16384
  ds_read_b64_tr_b16 v[210:211], v247 offset:16640
  v_exp_f32 v168, v168
  v_exp_f32 v169, v169
  v_exp_f32 v170, v170
  s_waitcnt lgkmcnt(10)
  v_mfma_f32_32x32x16_bf16 v[128:143], v[68:71], v[196:199], v[128:143]
  ds_read_b64_tr_b16 v[212:213], v247 offset:24576
  ds_read_b64_tr_b16 v[214:215], v247 offset:24832
  v_exp_f32 v171, v171
  v_fma_f32 v168, v168, v253, v253
  v_fma_f32 v169, v169, v253, v253
  v_fma_f32 v170, v170, v253, v253
  v_fma_f32 v171, v171, v253, v253
  s_waitcnt lgkmcnt(10)
  v_mfma_f32_32x32x16_bf16 v[128:143], v[56:59], v[200:203], v[128:143]
  s_waitcnt vmcnt(3)
  s_barrier
  ds_read_b64_tr_b16 v[192:193], v244 offset:32768
  ds_read_b64_tr_b16 v[194:195], v244 offset:33024
  v_rcp_f32 v168, v168
  v_rcp_f32 v169, v169
  v_rcp_f32 v170, v170
  s_waitcnt lgkmcnt(10)
  v_mfma_f32_32x32x16_bf16 v[128:143], v[72:75], v[204:207], v[128:143]
  ds_read_b64_tr_b16 v[196:197], v244 offset:40960
  ds_read_b64_tr_b16 v[198:199], v244 offset:41216
  v_rcp_f32 v171, v171
  v_mul_f32 v168, v168, v184
  v_mul_f32 v169, v169, v185
  v_mul_f32 v170, v170, v186
  v_mul_f32 v171, v171, v187
  s_waitcnt lgkmcnt(6)
  v_mfma_f32_32x32x16_bf16 v[128:143], v[60:63], v[208:211], v[128:143]
  ds_read_b64_tr_b16 v[200:201], v245 offset:32768
  ds_read_b64_tr_b16 v[202:203], v245 offset:33024
  v_cvt_pk_bf16_f32 v180, v168, v169
  v_cvt_pk_bf16_f32 v181, v170, v171
  v_mul_f32 v172, v252, v172
  v_mul_f32 v173, v252, v173
  v_mul_f32 v174, v252, v174
  v_mul_f32 v175, v252, v175
  s_waitcnt lgkmcnt(6)
  v_mfma_f32_32x32x16_bf16 v[128:143], v[76:79], v[212:215], v[128:143]
  ds_read_b64_tr_b16 v[204:205], v245 offset:40960
  ds_read_b64_tr_b16 v[206:207], v245 offset:41216
  v_exp_f32 v172, v172
  v_exp_f32 v173, v173
  v_exp_f32 v174, v174
  s_waitcnt lgkmcnt(6)
  v_mfma_f32_32x32x16_bf16 v[128:143], v[80:83], v[192:195], v[128:143]
  ds_read_b64_tr_b16 v[208:209], v246 offset:32768
  ds_read_b64_tr_b16 v[210:211], v246 offset:33024
  v_mfma_f32_16x16x32_bf16 v[216:219], v[232:235], v[192:195], v[216:219]
  v_exp_f32 v175, v175
  v_fma_f32 v172, v172, v253, v253
  v_fma_f32 v173, v173, v253, v253
  v_fma_f32 v174, v174, v253, v253
  v_fma_f32 v175, v175, v253, v253
  s_waitcnt lgkmcnt(6)
  v_mfma_f32_32x32x16_bf16 v[128:143], v[96:99], v[196:199], v[128:143]
  ds_read_b64_tr_b16 v[212:213], v246 offset:40960
  ds_read_b64_tr_b16 v[214:215], v246 offset:41216
  v_mfma_f32_16x16x32_bf16 v[216:219], v[232:235], v[196:199], v[216:219]
  v_rcp_f32 v172, v172
  v_rcp_f32 v173, v173
  v_rcp_f32 v174, v174
  s_waitcnt lgkmcnt(6)
  v_mfma_f32_32x32x16_bf16 v[128:143], v[84:87], v[200:203], v[128:143]
  ds_read_b64_tr_b16 v[192:193], v247 offset:32768
  ds_read_b64_tr_b16 v[194:195], v247 offset:33024
  v_rcp_f32 v175, v175
  v_mul_f32 v172, v172, v188
  v_mul_f32 v173, v173, v189
  v_mul_f32 v174, v174, v190
  v_mul_f32 v175, v175, v191
  s_waitcnt lgkmcnt(6)
  v_mfma_f32_32x32x16_bf16 v[128:143], v[100:103], v[204:207], v[128:143]
  ds_read_b64_tr_b16 v[196:197], v247 offset:40960
  ds_read_b64_tr_b16 v[198:199], v247 offset:41216
  v_cvt_pk_bf16_f32 v182, v172, v173
  v_cvt_pk_bf16_f32 v183, v174, v175
  buffer_store_dwordx4 v[180:183], v1, s[64:67], s76 offen offset:1024 sc1
  s_waitcnt lgkmcnt(6)
  v_mfma_f32_32x32x16_bf16 v[128:143], v[88:91], v[208:211], v[128:143]
  ds_write_b32 v255, v216 offset:4096
  s_waitcnt lgkmcnt(0)
  s_barrier
  ds_read_b128 v[220:223], v3 offset:4096
  s_waitcnt lgkmcnt(6)
  v_mfma_f32_32x32x16_bf16 v[128:143], v[104:107], v[212:215], v[128:143]
  s_waitcnt lgkmcnt(4)
  v_mfma_f32_32x32x16_bf16 v[128:143], v[92:95], v[192:195], v[128:143]
  s_waitcnt lgkmcnt(2)
  v_mfma_f32_32x32x16_bf16 v[128:143], v[108:111], v[196:199], v[128:143]
  s_waitcnt lgkmcnt(0)
  v_add_f32 v220, v220, v221
  v_add_f32 v222, v222, v223
  v_add_f32 v220, v220, v222
  v_cvt_pk_bf16_f32 v221, v220, v220
  v_lshlrev_b32 v222, 16, v221
  v_sub_f32 v222, v220, v222
  v_cvt_pk_bf16_f32 v240, v220, v222
  s_nop 1
  v_mfma_f32_32x32x16_bf16 v[128:143], v[236:239], v[240:243], v[128:143]
  s_nop 11
  v_mul_f32 v128, v112, v128
  v_mul_f32 v129, v113, v129
  v_cvt_pk_bf16_f32 v128, v128, v129
  v_mul_f32 v130, v114, v130
  v_mul_f32 v131, v115, v131
  v_cvt_pk_bf16_f32 v129, v130, v131
  v_mul_f32 v132, v116, v132
  v_mul_f32 v133, v117, v133
  v_cvt_pk_bf16_f32 v130, v132, v133
  v_mul_f32 v134, v118, v134
  v_mul_f32 v135, v119, v135
  v_cvt_pk_bf16_f32 v131, v134, v135
  v_mul_f32 v136, v120, v136
  v_mul_f32 v137, v121, v137
  v_cvt_pk_bf16_f32 v132, v136, v137
  v_mul_f32 v138, v122, v138
  v_mul_f32 v139, v123, v139
  v_cvt_pk_bf16_f32 v133, v138, v139
  v_mul_f32 v140, v124, v140
  v_mul_f32 v141, v125, v141
  v_cvt_pk_bf16_f32 v134, v140, v141
  v_mul_f32 v142, v126, v142
  v_mul_f32 v143, v127, v143
  v_cvt_pk_bf16_f32 v135, v142, v143
  s_mov_b64 exec, s[86:87]
  v_mov_b32 v128, 0x3f803f80
  v_mov_b32 v129, 0x3f803f80
  v_mov_b32 v130, 0x3f803f80
  v_mov_b32 v131, 0x3f803f80
  v_mov_b32 v132, 0x3f803f80
  v_mov_b32 v133, 0x3f803f80
  v_mov_b32 v134, 0x3f803f80
  v_mov_b32 v135, 0x3f803f80
  s_mov_b64 exec, s[88:89]
  v_mov_b32 v128, 0
  v_mov_b32 v129, 0
  v_mov_b32 v130, 0
  v_mov_b32 v131, 0
  v_mov_b32 v132, 0
  v_mov_b32 v133, 0
  v_mov_b32 v134, 0
  v_mov_b32 v135, 0
  s_mov_b64 exec, -1
  buffer_store_dwordx4 v[128:131], v1, s[64:67], s78 offen sc1
  buffer_store_dwordx4 v[132:135], v1, s[64:67], s78 offen offset:1024 sc1
  s_endpgm
L_k1_exit:
  s_endpgm

.globl attn_kernel
.p2align 8
.type attn_kernel,@function
attn_kernel:
  s_cmp_ge_u32 s2, 128
  s_cbranch_scc1 L_k2_exit
  s_lshl_b32 s3, s3, 7
  s_add_u32 s2, s2, s3
  s_load_dwordx2 s[36:37], s[0:1], 72
  s_load_dwordx2 s[40:41], s[0:1], 72
  v_lshrrev_b32 v1, 6, v0
  v_and_b32 v0, 63, v0
  s_and_b32 s4, s2, 7
  v_readfirstlane_b32 s3, v1
  s_lshr_b32 s5, s2, 3
  v_lshlrev_b32 v1, 4, v0
  v_mov_b32 v2, 100352
  v_mov_b32 v4, 0
  v_mov_b32 v5, 0
  v_mov_b32 v6, 0
  v_mov_b32 v7, 0
  ds_write_b128 v2, v[4:7]
  ds_write_b128 v2, v[4:7] offset:16
  s_mov_b32 s44, 0
  s_mov_b32 s45, -1
  s_mov_b32 s38, 20971520
  s_mov_b32 s39, 0x00020000
  s_mov_b32 s42, 20971520
  s_mov_b32 s43, 0x00020000
  s_mov_b32 s59, s3
  s_cmp_ge_u32 s3, 4
  s_cbranch_scc1 L_k2_gemm
  s_setprio 2
  s_lshl_b32 s6, s4, 1
  s_lshr_b32 s7, s5, 4
  s_add_u32 s6, s6, s7
  s_and_b32 s7, s5, 15
  s_lshl_b32 s8, s6, 17
  s_lshl_b32 s9, s7, 13
  s_add_u32 s8, s8, s9
  s_lshl_b32 s9, s3, 11
  s_add_u32 s19, s8, s9
  s_xor_b32 s16, s19, 6144
  s_xor_b32 s17, s19, 4096
  s_xor_b32 s18, s19, 2048
  s_lshl_b32 s10, s6, 18
  s_lshl_b32 s11, s3, 16
  s_add_u32 s10, s10, s11
  s_add_u32 s10, s10, 2097152
  s_mov_b32 s12, s10
  s_mov_b32 s14, 0
  s_waitcnt lgkmcnt(0)
  buffer_load_dwordx4 v[112:115], v1, s[40:43], s12 offen offset:0
  buffer_load_dwordx4 v[116:119], v1, s[40:43], s12 offen offset:1024
  buffer_load_dwordx4 v[16:19], v1, s[36:39], s16 offen offset:0
  buffer_load_dwordx4 v[20:23], v1, s[36:39], s16 offen offset:1024
  buffer_load_dwordx4 v[24:27], v1, s[36:39], s17 offen offset:0
  buffer_load_dwordx4 v[28:31], v1, s[36:39], s17 offen offset:1024
  buffer_load_dwordx4 v[120:123], v1, s[40:43], s12 offen offset:2048
  buffer_load_dwordx4 v[124:127], v1, s[40:43], s12 offen offset:3072
  s_add_u32 s12, s12, 4096
  buffer_load_dwordx4 v[32:35], v1, s[36:39], s18 offen offset:0
  buffer_load_dwordx4 v[36:39], v1, s[36:39], s18 offen offset:1024
  buffer_load_dwordx4 v[40:43], v1, s[36:39], s19 offen offset:0
  buffer_load_dwordx4 v[44:47], v1, s[36:39], s19 offen offset:1024
  s_barrier
  buffer_load_dwordx4 v[128:131], v1, s[40:43], s12 offen offset:0
  buffer_load_dwordx4 v[132:135], v1, s[40:43], s12 offen offset:1024
  buffer_load_dwordx4 v[136:139], v1, s[40:43], s12 offen offset:2048
  buffer_load_dwordx4 v[140:143], v1, s[40:43], s12 offen offset:3072
  s_add_u32 s12, s12, 4096
  buffer_load_dwordx4 v[144:147], v1, s[40:43], s12 offen offset:0
  v_mov_b32 v48, 0
  v_mov_b32 v49, 0
  v_mov_b32 v50, 0
  v_mov_b32 v51, 0
  v_mov_b32 v52, 0
  v_mov_b32 v53, 0
  v_mov_b32 v54, 0
  v_mov_b32 v55, 0
  v_mov_b32 v56, 0
  v_mov_b32 v57, 0
  v_mov_b32 v58, 0
  v_mov_b32 v59, 0
  v_mov_b32 v60, 0
  v_mov_b32 v61, 0
  v_mov_b32 v62, 0
  v_mov_b32 v63, 0
  v_mov_b32 v64, 0
  v_mov_b32 v65, 0
  v_mov_b32 v66, 0
  v_mov_b32 v67, 0
  v_mov_b32 v68, 0
  v_mov_b32 v69, 0
  v_mov_b32 v70, 0
  v_mov_b32 v71, 0
  v_mov_b32 v72, 0
  v_mov_b32 v73, 0
  v_mov_b32 v74, 0
  v_mov_b32 v75, 0
  v_mov_b32 v76, 0
  v_mov_b32 v77, 0
  v_mov_b32 v78, 0
  v_mov_b32 v79, 0
  v_mov_b32 v80, 0
  v_mov_b32 v81, 0
  v_mov_b32 v82, 0
  v_mov_b32 v83, 0
  v_mov_b32 v84, 0
  v_mov_b32 v85, 0
  v_mov_b32 v86, 0
  v_mov_b32 v87, 0
  v_mov_b32 v88, 0
  v_mov_b32 v89, 0
  v_mov_b32 v90, 0
  v_mov_b32 v91, 0
  v_mov_b32 v92, 0
  v_mov_b32 v93, 0
  v_mov_b32 v94, 0
  v_mov_b32 v95, 0
  v_mov_b32 v96, 0
  v_mov_b32 v97, 0
  v_mov_b32 v98, 0
  v_mov_b32 v99, 0
  v_mov_b32 v100, 0
  v_mov_b32 v101, 0
  v_mov_b32 v102, 0
  v_mov_b32 v103, 0
  v_mov_b32 v104, 0
  v_mov_b32 v105, 0
  v_mov_b32 v106, 0
  v_mov_b32 v107, 0
  v_mov_b32 v108, 0
  v_mov_b32 v109, 0
  v_mov_b32 v110, 0
  v_mov_b32 v111, 0
  v_mov_b32 v224, 0
  v_mov_b32 v225, 0
  v_mov_b32 v226, 0
  v_mov_b32 v227, 0
  v_and_b32 v3, 31, v0
  v_lshlrev_b32 v3, 2, v3
  s_xor_b32 s15, s3, 3
  s_mul_i32 s20, s15, 12288
  s_add_u32 s20, s20, 0
  v_add_u32 v228, s20, v1
  s_lshl_b32 s20, s15, 9
  s_add_u32 s20, s20, 98304
  v_add_u32 v231, s20, v3
  s_xor_b32 s15, s3, 2
  s_mul_i32 s20, s15, 12288
  s_add_u32 s20, s20, 4096
  v_add_u32 v229, s20, v1
  s_lshl_b32 s20, s15, 9
  s_add_u32 s20, s20, 98432
  v_add_u32 v232, s20, v3
  s_xor_b32 s15, s3, 1
  s_mul_i32 s20, s15, 12288
  s_add_u32 s20, s20, 8192
  v_add_u32 v230, s20, v1
  s_lshl_b32 s20, s15, 9
  s_add_u32 s20, s20, 98560
  v_add_u32 v233, s20, v3
  s_waitcnt vmcnt(13)
  s_branch L_k2_go
L_k2_main:
  v_mov_b32 v4, v224
  v_mov_b32 v5, v225
  v_mov_b32 v6, v226
  v_mov_b32 v7, v227
  v_permlane32_swap_b32 v4, v224
  v_permlane32_swap_b32 v5, v225
  v_permlane32_swap_b32 v6, v226
  v_permlane32_swap_b32 v7, v227
  v_max_f32 v224, v224, v4
  v_max_f32 v225, v225, v5
  v_max_f32 v226, v226, v6
  v_max_f32 v227, v227, v7
  s_mov_b64 exec, s[44:45]
  v_cvt_pk_bf16_f32 v4, -v224, -v224
  v_lshlrev_b32 v4, 16, v4
  v_sub_f32 v5, -v224, v4
  v_cvt_pk_bf16_f32 v22, -v224, v5
  v_and_b32 v6, 0xffff0000, v22
  v_sub_f32 v5, v5, v6
  v_cvt_pk_bf16_f32 v23, v5, 0
  v_cvt_pk_bf16_f32 v4, -v225, -v225
  v_lshlrev_b32 v4, 16, v4
  v_sub_f32 v5, -v225, v4
  v_cvt_pk_bf16_f32 v30, -v225, v5
  v_and_b32 v6, 0xffff0000, v30
  v_sub_f32 v5, v5, v6
  v_cvt_pk_bf16_f32 v31, v5, 0
  v_cvt_pk_bf16_f32 v4, -v226, -v226
  v_lshlrev_b32 v4, 16, v4
  v_sub_f32 v5, -v226, v4
  v_cvt_pk_bf16_f32 v38, -v226, v5
  v_and_b32 v6, 0xffff0000, v38
  v_sub_f32 v5, v5, v6
  v_cvt_pk_bf16_f32 v39, v5, 0
  v_cvt_pk_bf16_f32 v4, -v227, -v227
  v_lshlrev_b32 v4, 16, v4
  v_sub_f32 v5, -v227, v4
  v_cvt_pk_bf16_f32 v46, -v227, v5
  v_and_b32 v6, 0xffff0000, v46
  v_sub_f32 v5, v5, v6
  v_cvt_pk_bf16_f32 v47, v5, 0
  s_mov_b64 exec, -1
L_k2_go:
  v_mfma_f32_32x32x16_bf16 v[176:191], v[112:115], v[16:19], 0
  v_mfma_f32_32x32x16_bf16 v[176:191], v[116:119], v[20:23], v[176:191]
  s_mov_b32 s13, 0
  s_waitcnt vmcnt(11)
  v_mfma_f32_32x32x16_bf16 v[192:207], v[112:115], v[24:27], 0
  s_nop 8
  v_exp_f32 v176, v176
  v_exp_f32 v177, v177
  v_exp_f32 v178, v178
  v_mfma_f32_32x32x16_bf16 v[192:207], v[116:119], v[28:31], v[192:207]
  v_exp_f32 v179, v179
  v_exp_f32 v180, v180
  v_exp_f32 v181, v181
  v_exp_f32 v182, v182
  v_exp_f32 v183, v183
  v_cvt_pk_bf16_f32 v208, v176, v177
  v_cvt_pk_bf16_f32 v209, v178, v179
  v_cvt_pk_bf16_f32 v210, v180, v181
  v_cvt_pk_bf16_f32 v211, v182, v183
  v_exp_f32 v184, v184
  v_exp_f32 v185, v185
  v_exp_f32 v186, v186
  buffer_load_dwordx4 v[148:151], v1, s[40:43], s12 offen offset:1024
  v_exp_f32 v187, v187
  v_exp_f32 v188, v188
  v_exp_f32 v189, v189
  v_exp_f32 v190, v190
  v_exp_f32 v191, v191
  v_cvt_pk_bf16_f32 v212, v184, v185
  v_cvt_pk_bf16_f32 v213, v186, v187
  v_cvt_pk_bf16_f32 v214, v188, v189
  v_cvt_pk_bf16_f32 v215, v190, v191
L_k2_loop:
  s_waitcnt vmcnt(6)
  v_mfma_f32_32x32x16_bf16 v[176:191], v[112:115], v[32:35], 0
  v_exp_f32 v192, v192
  v_exp_f32 v193, v193
  v_exp_f32 v194, v194
  v_mfma_f32_32x32x16_bf16 v[176:191], v[116:119], v[36:39], v[176:191]
  v_exp_f32 v195, v195
  v_exp_f32 v196, v196
  v_exp_f32 v197, v197
  v_exp_f32 v198, v198
  v_exp_f32 v199, v199
  v_cvt_pk_bf16_f32 v216, v192, v193
  v_cvt_pk_bf16_f32 v217, v194, v195
  v_cvt_pk_bf16_f32 v218, v196, v197
  v_cvt_pk_bf16_f32 v219, v198, v199
  v_mfma_f32_32x32x16_bf16 v[48:63], v[120:123], v[208:211], v[48:63]
  v_exp_f32 v200, v200
  v_exp_f32 v201, v201
  v_exp_f32 v202, v202
  v_mfma_f32_32x32x16_bf16 v[48:63], v[124:127], v[212:215], v[48:63]
  buffer_load_dwordx4 v[152:155], v1, s[40:43], s12 offen offset:2048
  v_exp_f32 v203, v203
  v_exp_f32 v204, v204
  v_exp_f32 v205, v205
  v_exp_f32 v206, v206
  v_exp_f32 v207, v207
  v_cvt_pk_bf16_f32 v220, v200, v201
  v_cvt_pk_bf16_f32 v221, v202, v203
  v_cvt_pk_bf16_f32 v222, v204, v205
  v_cvt_pk_bf16_f32 v223, v206, v207
  s_waitcnt vmcnt(7)
  v_mfma_f32_32x32x16_bf16 v[192:207], v[112:115], v[40:43], 0
  v_exp_f32 v176, v176
  v_exp_f32 v177, v177
  v_exp_f32 v178, v178
  v_mfma_f32_32x32x16_bf16 v[192:207], v[116:119], v[44:47], v[192:207]
  v_exp_f32 v179, v179
  v_exp_f32 v180, v180
  v_exp_f32 v181, v181
  v_exp_f32 v182, v182
  v_exp_f32 v183, v183
  v_cvt_pk_bf16_f32 v208, v176, v177
  v_cvt_pk_bf16_f32 v209, v178, v179
  v_cvt_pk_bf16_f32 v210, v180, v181
  v_cvt_pk_bf16_f32 v211, v182, v183
  v_mfma_f32_32x32x16_bf16 v[64:79], v[120:123], v[216:219], v[64:79]
  v_exp_f32 v184, v184
  v_exp_f32 v185, v185
  v_exp_f32 v186, v186
  v_mfma_f32_32x32x16_bf16 v[64:79], v[124:127], v[220:223], v[64:79]
  buffer_load_dwordx4 v[156:159], v1, s[40:43], s12 offen offset:3072
  s_add_u32 s12, s12, 4096
  v_exp_f32 v187, v187
  v_exp_f32 v188, v188
  v_exp_f32 v189, v189
  v_exp_f32 v190, v190
  v_exp_f32 v191, v191
  v_cvt_pk_bf16_f32 v212, v184, v185
  v_cvt_pk_bf16_f32 v213, v186, v187
  v_cvt_pk_bf16_f32 v214, v188, v189
  v_cvt_pk_bf16_f32 v215, v190, v191
  s_waitcnt vmcnt(6)
  v_mfma_f32_32x32x16_bf16 v[176:191], v[128:131], v[16:19], 0
  v_exp_f32 v192, v192
  v_exp_f32 v193, v193
  v_exp_f32 v194, v194
  v_mfma_f32_32x32x16_bf16 v[176:191], v[132:135], v[20:23], v[176:191]
  v_exp_f32 v195, v195
  v_exp_f32 v196, v196
  v_exp_f32 v197, v197
  v_exp_f32 v198, v198
  v_exp_f32 v199, v199
  v_cvt_pk_bf16_f32 v216, v192, v193
  v_cvt_pk_bf16_f32 v217, v194, v195
  v_cvt_pk_bf16_f32 v218, v196, v197
  v_cvt_pk_bf16_f32 v219, v198, v199
  v_mfma_f32_32x32x16_bf16 v[80:95], v[120:123], v[208:211], v[80:95]
  v_exp_f32 v200, v200
  v_exp_f32 v201, v201
  v_exp_f32 v202, v202
  v_mfma_f32_32x32x16_bf16 v[80:95], v[124:127], v[212:215], v[80:95]
  buffer_load_dwordx4 v[160:163], v1, s[40:43], s12 offen offset:0
  v_exp_f32 v203, v203
  v_exp_f32 v204, v204
  v_exp_f32 v205, v205
  v_exp_f32 v206, v206
  v_exp_f32 v207, v207
  v_cvt_pk_bf16_f32 v220, v200, v201
  v_cvt_pk_bf16_f32 v221, v202, v203
  v_cvt_pk_bf16_f32 v222, v204, v205
  v_cvt_pk_bf16_f32 v223, v206, v207
  v_mfma_f32_32x32x16_bf16 v[192:207], v[128:131], v[24:27], 0
  v_exp_f32 v176, v176
  v_exp_f32 v177, v177
  v_exp_f32 v178, v178
  v_mfma_f32_32x32x16_bf16 v[192:207], v[132:135], v[28:31], v[192:207]
  v_exp_f32 v179, v179
  v_exp_f32 v180, v180
  v_exp_f32 v181, v181
  v_exp_f32 v182, v182
  v_exp_f32 v183, v183
  v_cvt_pk_bf16_f32 v208, v176, v177
  v_cvt_pk_bf16_f32 v209, v178, v179
  v_cvt_pk_bf16_f32 v210, v180, v181
  v_cvt_pk_bf16_f32 v211, v182, v183
  v_mfma_f32_32x32x16_bf16 v[96:111], v[120:123], v[216:219], v[96:111]
  v_exp_f32 v184, v184
  v_exp_f32 v185, v185
  v_exp_f32 v186, v186
  v_mfma_f32_32x32x16_bf16 v[96:111], v[124:127], v[220:223], v[96:111]
  buffer_load_dwordx4 v[164:167], v1, s[40:43], s12 offen offset:1024
  v_exp_f32 v187, v187
  v_exp_f32 v188, v188
  v_exp_f32 v189, v189
  v_exp_f32 v190, v190
  v_exp_f32 v191, v191
  v_cvt_pk_bf16_f32 v212, v184, v185
  v_cvt_pk_bf16_f32 v213, v186, v187
  v_cvt_pk_bf16_f32 v214, v188, v189
  v_cvt_pk_bf16_f32 v215, v190, v191
  s_waitcnt vmcnt(6)
  v_mfma_f32_32x32x16_bf16 v[176:191], v[128:131], v[32:35], 0
  v_exp_f32 v192, v192
  v_exp_f32 v193, v193
  v_exp_f32 v194, v194
  v_mfma_f32_32x32x16_bf16 v[176:191], v[132:135], v[36:39], v[176:191]
  v_exp_f32 v195, v195
  v_exp_f32 v196, v196
  v_exp_f32 v197, v197
  v_exp_f32 v198, v198
  v_exp_f32 v199, v199
  v_cvt_pk_bf16_f32 v216, v192, v193
  v_cvt_pk_bf16_f32 v217, v194, v195
  v_cvt_pk_bf16_f32 v218, v196, v197
  v_cvt_pk_bf16_f32 v219, v198, v199
  v_mfma_f32_32x32x16_bf16 v[48:63], v[136:139], v[208:211], v[48:63]
  v_exp_f32 v200, v200
  v_exp_f32 v201, v201
  v_exp_f32 v202, v202
  v_mfma_f32_32x32x16_bf16 v[48:63], v[140:143], v[212:215], v[48:63]
  buffer_load_dwordx4 v[168:171], v1, s[40:43], s12 offen offset:2048
  v_exp_f32 v203, v203
  v_exp_f32 v204, v204
  v_exp_f32 v205, v205
  v_exp_f32 v206, v206
  v_exp_f32 v207, v207
  v_cvt_pk_bf16_f32 v220, v200, v201
  v_cvt_pk_bf16_f32 v221, v202, v203
  v_cvt_pk_bf16_f32 v222, v204, v205
  v_cvt_pk_bf16_f32 v223, v206, v207
  v_mfma_f32_32x32x16_bf16 v[192:207], v[128:131], v[40:43], 0
  v_exp_f32 v176, v176
  v_exp_f32 v177, v177
  v_exp_f32 v178, v178
  v_mfma_f32_32x32x16_bf16 v[192:207], v[132:135], v[44:47], v[192:207]
  v_exp_f32 v179, v179
  v_exp_f32 v180, v180
  v_exp_f32 v181, v181
  v_exp_f32 v182, v182
  v_exp_f32 v183, v183
  v_cvt_pk_bf16_f32 v208, v176, v177
  v_cvt_pk_bf16_f32 v209, v178, v179
  v_cvt_pk_bf16_f32 v210, v180, v181
  v_cvt_pk_bf16_f32 v211, v182, v183
  v_mfma_f32_32x32x16_bf16 v[64:79], v[136:139], v[216:219], v[64:79]
  v_exp_f32 v184, v184
  v_exp_f32 v185, v185
  v_exp_f32 v186, v186
  v_mfma_f32_32x32x16_bf16 v[64:79], v[140:143], v[220:223], v[64:79]
  buffer_load_dwordx4 v[172:175], v1, s[40:43], s12 offen offset:3072
  s_add_u32 s12, s12, 4096
  v_exp_f32 v187, v187
  v_exp_f32 v188, v188
  v_exp_f32 v189, v189
  v_exp_f32 v190, v190
  v_exp_f32 v191, v191
  v_cvt_pk_bf16_f32 v212, v184, v185
  v_cvt_pk_bf16_f32 v213, v186, v187
  v_cvt_pk_bf16_f32 v214, v188, v189
  v_cvt_pk_bf16_f32 v215, v190, v191
  s_waitcnt vmcnt(6)
  v_mfma_f32_32x32x16_bf16 v[176:191], v[144:147], v[16:19], 0
  v_exp_f32 v192, v192
  v_exp_f32 v193, v193
  v_exp_f32 v194, v194
  v_mfma_f32_32x32x16_bf16 v[176:191], v[148:151], v[20:23], v[176:191]
  v_exp_f32 v195, v195
  v_exp_f32 v196, v196
  v_exp_f32 v197, v197
  v_exp_f32 v198, v198
  v_exp_f32 v199, v199
  v_cvt_pk_bf16_f32 v216, v192, v193
  v_cvt_pk_bf16_f32 v217, v194, v195
  v_cvt_pk_bf16_f32 v218, v196, v197
  v_cvt_pk_bf16_f32 v219, v198, v199
  v_mfma_f32_32x32x16_bf16 v[80:95], v[136:139], v[208:211], v[80:95]
  v_exp_f32 v200, v200
  v_exp_f32 v201, v201
  v_exp_f32 v202, v202
  v_mfma_f32_32x32x16_bf16 v[80:95], v[140:143], v[212:215], v[80:95]
  s_cmp_eq_u32 s13, 3
  s_cselect_b32 s42, 0, 20971520
  buffer_load_dwordx4 v[112:115], v1, s[40:43], s12 offen offset:0
  v_exp_f32 v203, v203
  v_exp_f32 v204, v204
  v_exp_f32 v205, v205
  v_exp_f32 v206, v206
  v_exp_f32 v207, v207
  v_cvt_pk_bf16_f32 v220, v200, v201
  v_cvt_pk_bf16_f32 v221, v202, v203
  v_cvt_pk_bf16_f32 v222, v204, v205
  v_cvt_pk_bf16_f32 v223, v206, v207
  v_mfma_f32_32x32x16_bf16 v[192:207], v[144:147], v[24:27], 0
  v_exp_f32 v176, v176
  v_exp_f32 v177, v177
  v_exp_f32 v178, v178
  v_mfma_f32_32x32x16_bf16 v[192:207], v[148:151], v[28:31], v[192:207]
  v_exp_f32 v179, v179
  v_exp_f32 v180, v180
  v_exp_f32 v181, v181
  v_exp_f32 v182, v182
  v_exp_f32 v183, v183
  v_cvt_pk_bf16_f32 v208, v176, v177
  v_cvt_pk_bf16_f32 v209, v178, v179
  v_cvt_pk_bf16_f32 v210, v180, v181
  v_cvt_pk_bf16_f32 v211, v182, v183
  v_mfma_f32_32x32x16_bf16 v[96:111], v[136:139], v[216:219], v[96:111]
  v_exp_f32 v184, v184
  v_exp_f32 v185, v185
  v_exp_f32 v186, v186
  v_mfma_f32_32x32x16_bf16 v[96:111], v[140:143], v[220:223], v[96:111]
  buffer_load_dwordx4 v[116:119], v1, s[40:43], s12 offen offset:1024
  v_exp_f32 v187, v187
  v_exp_f32 v188, v188
  v_exp_f32 v189, v189
  v_exp_f32 v190, v190
  v_exp_f32 v191, v191
  v_cvt_pk_bf16_f32 v212, v184, v185
  v_cvt_pk_bf16_f32 v213, v186, v187
  v_cvt_pk_bf16_f32 v214, v188, v189
  v_cvt_pk_bf16_f32 v215, v190, v191
  s_waitcnt vmcnt(6)
  v_mfma_f32_32x32x16_bf16 v[176:191], v[144:147], v[32:35], 0
  v_exp_f32 v192, v192
  v_exp_f32 v193, v193
  v_exp_f32 v194, v194
  v_mfma_f32_32x32x16_bf16 v[176:191], v[148:151], v[36:39], v[176:191]
  v_exp_f32 v195, v195
  v_exp_f32 v196, v196
  v_exp_f32 v197, v197
  v_exp_f32 v198, v198
  v_exp_f32 v199, v199
  v_cvt_pk_bf16_f32 v216, v192, v193
  v_cvt_pk_bf16_f32 v217, v194, v195
  v_cvt_pk_bf16_f32 v218, v196, v197
  v_cvt_pk_bf16_f32 v219, v198, v199
  v_mfma_f32_32x32x16_bf16 v[48:63], v[152:155], v[208:211], v[48:63]
  v_exp_f32 v200, v200
  v_exp_f32 v201, v201
  v_exp_f32 v202, v202
  v_mfma_f32_32x32x16_bf16 v[48:63], v[156:159], v[212:215], v[48:63]
  buffer_load_dwordx4 v[120:123], v1, s[40:43], s12 offen offset:2048
  v_exp_f32 v203, v203
  v_exp_f32 v204, v204
  v_exp_f32 v205, v205
  v_exp_f32 v206, v206
  v_exp_f32 v207, v207
  v_cvt_pk_bf16_f32 v220, v200, v201
  v_cvt_pk_bf16_f32 v221, v202, v203
  v_cvt_pk_bf16_f32 v222, v204, v205
  v_cvt_pk_bf16_f32 v223, v206, v207
  v_mfma_f32_32x32x16_bf16 v[192:207], v[144:147], v[40:43], 0
  v_exp_f32 v176, v176
  v_exp_f32 v177, v177
  v_exp_f32 v178, v178
  v_mfma_f32_32x32x16_bf16 v[192:207], v[148:151], v[44:47], v[192:207]
  v_exp_f32 v179, v179
  v_exp_f32 v180, v180
  v_exp_f32 v181, v181
  v_exp_f32 v182, v182
  v_exp_f32 v183, v183
  v_cvt_pk_bf16_f32 v208, v176, v177
  v_cvt_pk_bf16_f32 v209, v178, v179
  v_cvt_pk_bf16_f32 v210, v180, v181
  v_cvt_pk_bf16_f32 v211, v182, v183
  v_mfma_f32_32x32x16_bf16 v[64:79], v[152:155], v[216:219], v[64:79]
  v_exp_f32 v184, v184
  v_exp_f32 v185, v185
  v_exp_f32 v186, v186
  v_mfma_f32_32x32x16_bf16 v[64:79], v[156:159], v[220:223], v[64:79]
  buffer_load_dwordx4 v[124:127], v1, s[40:43], s12 offen offset:3072
  s_add_u32 s12, s12, 4096
  v_exp_f32 v187, v187
  v_exp_f32 v188, v188
  v_exp_f32 v189, v189
  v_exp_f32 v190, v190
  v_exp_f32 v191, v191
  v_cvt_pk_bf16_f32 v212, v184, v185
  v_cvt_pk_bf16_f32 v213, v186, v187
  v_cvt_pk_bf16_f32 v214, v188, v189
  v_cvt_pk_bf16_f32 v215, v190, v191
  s_waitcnt vmcnt(6)
  v_mfma_f32_32x32x16_bf16 v[176:191], v[160:163], v[16:19], 0
  v_exp_f32 v192, v192
  v_exp_f32 v193, v193
  v_exp_f32 v194, v194
  v_mfma_f32_32x32x16_bf16 v[176:191], v[164:167], v[20:23], v[176:191]
  v_exp_f32 v195, v195
  v_exp_f32 v196, v196
  v_exp_f32 v197, v197
  v_exp_f32 v198, v198
  v_exp_f32 v199, v199
  v_cvt_pk_bf16_f32 v216, v192, v193
  v_cvt_pk_bf16_f32 v217, v194, v195
  v_cvt_pk_bf16_f32 v218, v196, v197
  v_cvt_pk_bf16_f32 v219, v198, v199
  v_mfma_f32_32x32x16_bf16 v[80:95], v[152:155], v[208:211], v[80:95]
  v_exp_f32 v200, v200
  v_exp_f32 v201, v201
  v_exp_f32 v202, v202
  v_mfma_f32_32x32x16_bf16 v[80:95], v[156:159], v[212:215], v[80:95]
  buffer_load_dwordx4 v[128:131], v1, s[40:43], s12 offen offset:0
  v_exp_f32 v203, v203
  v_exp_f32 v204, v204
  v_exp_f32 v205, v205
  v_exp_f32 v206, v206
  v_exp_f32 v207, v207
  v_cvt_pk_bf16_f32 v220, v200, v201
  v_cvt_pk_bf16_f32 v221, v202, v203
  v_cvt_pk_bf16_f32 v222, v204, v205
  v_cvt_pk_bf16_f32 v223, v206, v207
  v_mfma_f32_32x32x16_bf16 v[192:207], v[160:163], v[24:27], 0
  v_exp_f32 v176, v176
  v_exp_f32 v177, v177
  v_exp_f32 v178, v178
  v_mfma_f32_32x32x16_bf16 v[192:207], v[164:167], v[28:31], v[192:207]
  v_exp_f32 v179, v179
  v_exp_f32 v180, v180
  v_exp_f32 v181, v181
  v_exp_f32 v182, v182
  v_exp_f32 v183, v183
  v_cvt_pk_bf16_f32 v208, v176, v177
  v_cvt_pk_bf16_f32 v209, v178, v179
  v_cvt_pk_bf16_f32 v210, v180, v181
  v_cvt_pk_bf16_f32 v211, v182, v183
  v_mfma_f32_32x32x16_bf16 v[96:111], v[152:155], v[216:219], v[96:111]
  v_exp_f32 v184, v184
  v_exp_f32 v185, v185
  v_exp_f32 v186, v186
  v_mfma_f32_32x32x16_bf16 v[96:111], v[156:159], v[220:223], v[96:111]
  buffer_load_dwordx4 v[132:135], v1, s[40:43], s12 offen offset:1024
  v_exp_f32 v187, v187
  v_exp_f32 v188, v188
  v_exp_f32 v189, v189
  v_exp_f32 v190, v190
  v_exp_f32 v191, v191
  v_cvt_pk_bf16_f32 v212, v184, v185
  v_cvt_pk_bf16_f32 v213, v186, v187
  v_cvt_pk_bf16_f32 v214, v188, v189
  v_cvt_pk_bf16_f32 v215, v190, v191
  s_cmp_eq_u32 s13, 3
  s_cbranch_scc1 L_k2_done
  s_waitcnt vmcnt(6)
  v_mfma_f32_32x32x16_bf16 v[176:191], v[160:163], v[32:35], 0
  v_exp_f32 v192, v192
  v_exp_f32 v193, v193
  v_exp_f32 v194, v194
  v_mfma_f32_32x32x16_bf16 v[176:191], v[164:167], v[36:39], v[176:191]
  v_exp_f32 v195, v195
  v_exp_f32 v196, v196
  v_exp_f32 v197, v197
  v_exp_f32 v198, v198
  v_exp_f32 v199, v199
  v_cvt_pk_bf16_f32 v216, v192, v193
  v_cvt_pk_bf16_f32 v217, v194, v195
  v_cvt_pk_bf16_f32 v218, v196, v197
  v_cvt_pk_bf16_f32 v219, v198, v199
  v_mfma_f32_32x32x16_bf16 v[48:63], v[168:171], v[208:211], v[48:63]
  v_exp_f32 v200, v200
  v_exp_f32 v201, v201
  v_exp_f32 v202, v202
  v_mfma_f32_32x32x16_bf16 v[48:63], v[172:175], v[212:215], v[48:63]
  buffer_load_dwordx4 v[136:139], v1, s[40:43], s12 offen offset:2048
  v_exp_f32 v203, v203
  v_exp_f32 v204, v204
  v_exp_f32 v205, v205
  v_exp_f32 v206, v206
  v_exp_f32 v207, v207
  v_cvt_pk_bf16_f32 v220, v200, v201
  v_cvt_pk_bf16_f32 v221, v202, v203
  v_cvt_pk_bf16_f32 v222, v204, v205
  v_cvt_pk_bf16_f32 v223, v206, v207
  v_mfma_f32_32x32x16_bf16 v[192:207], v[160:163], v[40:43], 0
  v_exp_f32 v176, v176
  v_exp_f32 v177, v177
  v_exp_f32 v178, v178
  v_mfma_f32_32x32x16_bf16 v[192:207], v[164:167], v[44:47], v[192:207]
  v_exp_f32 v179, v179
  v_exp_f32 v180, v180
  v_exp_f32 v181, v181
  v_exp_f32 v182, v182
  v_exp_f32 v183, v183
  v_cvt_pk_bf16_f32 v208, v176, v177
  v_cvt_pk_bf16_f32 v209, v178, v179
  v_cvt_pk_bf16_f32 v210, v180, v181
  v_cvt_pk_bf16_f32 v211, v182, v183
  v_mfma_f32_32x32x16_bf16 v[64:79], v[168:171], v[216:219], v[64:79]
  v_exp_f32 v184, v184
  v_exp_f32 v185, v185
  v_exp_f32 v186, v186
  v_mfma_f32_32x32x16_bf16 v[64:79], v[172:175], v[220:223], v[64:79]
  buffer_load_dwordx4 v[140:143], v1, s[40:43], s12 offen offset:3072
  s_add_u32 s12, s12, 4096
  v_exp_f32 v187, v187
  v_exp_f32 v188, v188
  v_exp_f32 v189, v189
  v_exp_f32 v190, v190
  v_exp_f32 v191, v191
  v_cvt_pk_bf16_f32 v212, v184, v185
  v_cvt_pk_bf16_f32 v213, v186, v187
  v_cvt_pk_bf16_f32 v214, v188, v189
  v_cvt_pk_bf16_f32 v215, v190, v191
  s_waitcnt vmcnt(6)
  v_mfma_f32_32x32x16_bf16 v[176:191], v[112:115], v[16:19], 0
  v_exp_f32 v192, v192
  v_exp_f32 v193, v193
  v_exp_f32 v194, v194
  v_mfma_f32_32x32x16_bf16 v[176:191], v[116:119], v[20:23], v[176:191]
  v_exp_f32 v195, v195
  v_exp_f32 v196, v196
  v_exp_f32 v197, v197
  v_exp_f32 v198, v198
  v_exp_f32 v199, v199
  v_cvt_pk_bf16_f32 v216, v192, v193
  v_cvt_pk_bf16_f32 v217, v194, v195
  v_cvt_pk_bf16_f32 v218, v196, v197
  v_cvt_pk_bf16_f32 v219, v198, v199
  v_mfma_f32_32x32x16_bf16 v[80:95], v[168:171], v[208:211], v[80:95]
  v_exp_f32 v200, v200
  v_exp_f32 v201, v201
  v_exp_f32 v202, v202
  v_mfma_f32_32x32x16_bf16 v[80:95], v[172:175], v[212:215], v[80:95]
  buffer_load_dwordx4 v[144:147], v1, s[40:43], s12 offen offset:0
  v_exp_f32 v203, v203
  v_exp_f32 v204, v204
  v_exp_f32 v205, v205
  v_exp_f32 v206, v206
  v_exp_f32 v207, v207
  v_cvt_pk_bf16_f32 v220, v200, v201
  v_cvt_pk_bf16_f32 v221, v202, v203
  v_cvt_pk_bf16_f32 v222, v204, v205
  v_cvt_pk_bf16_f32 v223, v206, v207
  v_mfma_f32_32x32x16_bf16 v[192:207], v[112:115], v[24:27], 0
  v_exp_f32 v176, v176
  v_exp_f32 v177, v177
  v_exp_f32 v178, v178
  v_mfma_f32_32x32x16_bf16 v[192:207], v[116:119], v[28:31], v[192:207]
  v_exp_f32 v179, v179
  v_exp_f32 v180, v180
  v_exp_f32 v181, v181
  v_exp_f32 v182, v182
  v_exp_f32 v183, v183
  v_cvt_pk_bf16_f32 v208, v176, v177
  v_cvt_pk_bf16_f32 v209, v178, v179
  v_cvt_pk_bf16_f32 v210, v180, v181
  v_cvt_pk_bf16_f32 v211, v182, v183
  v_mfma_f32_32x32x16_bf16 v[96:111], v[168:171], v[216:219], v[96:111]
  v_exp_f32 v184, v184
  v_exp_f32 v185, v185
  v_exp_f32 v186, v186
  v_mfma_f32_32x32x16_bf16 v[96:111], v[172:175], v[220:223], v[96:111]
  buffer_load_dwordx4 v[148:151], v1, s[40:43], s12 offen offset:1024
  v_exp_f32 v187, v187
  v_exp_f32 v188, v188
  v_exp_f32 v189, v189
  v_exp_f32 v190, v190
  v_exp_f32 v191, v191
  v_cvt_pk_bf16_f32 v212, v184, v185
  v_cvt_pk_bf16_f32 v213, v186, v187
  v_cvt_pk_bf16_f32 v214, v188, v189
  v_cvt_pk_bf16_f32 v215, v190, v191
  s_add_u32 s13, s13, 1
  s_branch L_k2_loop
L_k2_done:
  s_waitcnt vmcnt(6)
  v_mfma_f32_32x32x16_bf16 v[48:63], v[168:171], v[208:211], v[48:63]
  v_exp_f32 v192, v192
  v_exp_f32 v193, v193
  v_exp_f32 v194, v194
  v_mfma_f32_32x32x16_bf16 v[48:63], v[172:175], v[212:215], v[48:63]
  v_exp_f32 v195, v195
  v_exp_f32 v196, v196
  v_exp_f32 v197, v197
  v_exp_f32 v198, v198
  v_exp_f32 v199, v199
  v_cvt_pk_bf16_f32 v216, v192, v193
  v_cvt_pk_bf16_f32 v217, v194, v195
  v_cvt_pk_bf16_f32 v218, v196, v197
  v_cvt_pk_bf16_f32 v219, v198, v199
  v_mfma_f32_32x32x16_bf16 v[176:191], v[160:163], v[32:35], 0
  v_exp_f32 v200, v200
  s_nop 0
  ds_write_b128 v228, v[48:51] offset:0
  v_exp_f32 v201, v201
  ds_write_b128 v228, v[52:55] offset:1024
  v_exp_f32 v202, v202
  ds_write_b128 v228, v[56:59] offset:2048
  v_mfma_f32_32x32x16_bf16 v[176:191], v[164:167], v[36:39], v[176:191]
  v_exp_f32 v203, v203
  ds_write_b128 v228, v[60:63] offset:3072
  v_exp_f32 v204, v204
  ds_write_b32 v231, v224
  v_exp_f32 v205, v205
  v_exp_f32 v206, v206
  v_exp_f32 v207, v207
  v_cvt_pk_bf16_f32 v220, v200, v201
  v_cvt_pk_bf16_f32 v221, v202, v203
  v_cvt_pk_bf16_f32 v222, v204, v205
  v_cvt_pk_bf16_f32 v223, v206, v207
  v_mfma_f32_32x32x16_bf16 v[64:79], v[168:171], v[216:219], v[64:79]
  v_exp_f32 v176, v176
  v_exp_f32 v177, v177
  v_exp_f32 v178, v178
  v_mfma_f32_32x32x16_bf16 v[64:79], v[172:175], v[220:223], v[64:79]
  v_exp_f32 v179, v179
  v_exp_f32 v180, v180
  v_exp_f32 v181, v181
  v_exp_f32 v182, v182
  v_exp_f32 v183, v183
  v_cvt_pk_bf16_f32 v208, v176, v177
  v_cvt_pk_bf16_f32 v209, v178, v179
  v_cvt_pk_bf16_f32 v210, v180, v181
  v_cvt_pk_bf16_f32 v211, v182, v183
  v_mfma_f32_32x32x16_bf16 v[192:207], v[160:163], v[40:43], 0
  v_exp_f32 v184, v184
  s_nop 0
  ds_write_b128 v229, v[64:67] offset:0
  v_exp_f32 v185, v185
  ds_write_b128 v229, v[68:71] offset:1024
  v_exp_f32 v186, v186
  ds_write_b128 v229, v[72:75] offset:2048
  v_mfma_f32_32x32x16_bf16 v[192:207], v[164:167], v[44:47], v[192:207]
  v_exp_f32 v187, v187
  ds_write_b128 v229, v[76:79] offset:3072
  v_exp_f32 v188, v188
  ds_write_b32 v232, v225
  v_exp_f32 v189, v189
  v_exp_f32 v190, v190
  v_exp_f32 v191, v191
  v_cvt_pk_bf16_f32 v212, v184, v185
  v_cvt_pk_bf16_f32 v213, v186, v187
  v_cvt_pk_bf16_f32 v214, v188, v189
  v_cvt_pk_bf16_f32 v215, v190, v191
  v_mfma_f32_32x32x16_bf16 v[80:95], v[168:171], v[208:211], v[80:95]
  v_exp_f32 v192, v192
  v_exp_f32 v193, v193
  v_exp_f32 v194, v194
  v_mfma_f32_32x32x16_bf16 v[80:95], v[172:175], v[212:215], v[80:95]
  v_exp_f32 v195, v195
  v_exp_f32 v196, v196
  v_exp_f32 v197, v197
  v_exp_f32 v198, v198
  v_exp_f32 v199, v199
  v_cvt_pk_bf16_f32 v216, v192, v193
  v_cvt_pk_bf16_f32 v217, v194, v195
  v_cvt_pk_bf16_f32 v218, v196, v197
  v_cvt_pk_bf16_f32 v219, v198, v199
  v_exp_f32 v200, v200
  s_nop 1
  ds_write_b128 v230, v[80:83] offset:0
  v_exp_f32 v201, v201
  ds_write_b128 v230, v[84:87] offset:1024
  v_exp_f32 v202, v202
  ds_write_b128 v230, v[88:91] offset:2048
  v_exp_f32 v203, v203
  ds_write_b128 v230, v[92:95] offset:3072
  v_exp_f32 v204, v204
  ds_write_b32 v233, v226
  v_exp_f32 v205, v205
  v_exp_f32 v206, v206
  v_exp_f32 v207, v207
  v_cvt_pk_bf16_f32 v220, v200, v201
  v_cvt_pk_bf16_f32 v221, v202, v203
  v_cvt_pk_bf16_f32 v222, v204, v205
  v_cvt_pk_bf16_f32 v223, v206, v207
  v_mfma_f32_32x32x16_bf16 v[96:111], v[168:171], v[216:219], v[96:111]
  s_nop 0
  v_mfma_f32_32x32x16_bf16 v[96:111], v[172:175], v[220:223], v[96:111]
  v_mov_b32 v5, 0x21800000
  s_mov_b32 s55, 0x5d800000
  s_mul_i32 s15, s3, 12288
  v_add_u32 v2, s15, v1
  s_lshl_b32 s15, s3, 9
  s_add_u32 s15, s15, 98304
  v_add_u32 v7, s15, v3
  v_mov_b32 v8, 100356
  v_mov_b32 v6, 1
  s_mov_b64 exec, s[44:45]
  v_med3_f32 v4, v60, v5, s55
  v_cmp_neq_f32 s[46:47], v4, v60
  v_med3_f32 v4, v76, v5, s55
  v_cmp_neq_f32 s[48:49], v4, v76
  v_med3_f32 v4, v92, v5, s55
  v_cmp_neq_f32 s[50:51], v4, v92
  v_med3_f32 v4, v108, v5, s55
  v_cmp_neq_f32 s[52:53], v4, v108
  s_mov_b64 exec, 1
  s_or_b64 s[46:47], s[46:47], s[48:49]
  s_or_b64 s[50:51], s[50:51], s[52:53]
  s_or_b64 s[46:47], s[46:47], s[50:51]
  s_cbranch_scc1 L_k2_slow
L_k2_comb:
  s_waitcnt lgkmcnt(0)
  ds_add_u32 v8, v6
  s_mov_b64 exec, -1
L_k2_apoll:
  ds_read_b32 v6, v8
  s_waitcnt lgkmcnt(0)
  v_readfirstlane_b32 s15, v6
  s_cmp_lt_u32 s15, 4
  s_cbranch_scc1 L_k2_apoll
  ds_read_b32 v8, v7 offset:0
  ds_read_b32 v9, v7 offset:128
  ds_read_b32 v10, v7 offset:256
  ds_read_b128 v[48:51], v2 offset:0
  ds_read_b128 v[52:55], v2 offset:1024
  ds_read_b128 v[56:59], v2 offset:2048
  ds_read_b128 v[60:63], v2 offset:3072
  ds_read_b128 v[64:67], v2 offset:4096
  ds_read_b128 v[68:71], v2 offset:5120
  ds_read_b128 v[72:75], v2 offset:6144
  ds_read_b128 v[76:79], v2 offset:7168
  ds_read_b128 v[80:83], v2 offset:8192
  ds_read_b128 v[84:87], v2 offset:9216
  ds_read_b128 v[88:91], v2 offset:10240
  ds_read_b128 v[92:95], v2 offset:11264
  s_lshl_b32 s15, s7, 2
  s_add_u32 s15, s15, s3
  s_lshl_b32 s15, s15, 15
  s_lshl_b32 s16, s6, 11
  s_add_u32 s15, s15, s16
  s_add_u32 s15, s15, 16777216
  s_waitcnt lgkmcnt(12)
  v_max3_f32 v12, v8, v9, v10
  v_max_f32 v12, v12, v227
  v_sub_f32 v8, v8, v12
  v_sub_f32 v9, v9, v12
  v_sub_f32 v10, v10, v12
  v_sub_f32 v11, v227, v12
  v_exp_f32 v11, v11
  v_exp_f32 v8, v8
  v_exp_f32 v9, v9
  v_exp_f32 v10, v10
  s_nop 0
  v_pk_mul_f32 v[96:97], v[10:11], v[96:97] op_sel:[1,0] op_sel_hi:[1,1]
  v_pk_mul_f32 v[98:99], v[10:11], v[98:99] op_sel:[1,0] op_sel_hi:[1,1]
  v_pk_mul_f32 v[100:101], v[10:11], v[100:101] op_sel:[1,0] op_sel_hi:[1,1]
  v_pk_mul_f32 v[102:103], v[10:11], v[102:103] op_sel:[1,0] op_sel_hi:[1,1]
  v_pk_mul_f32 v[104:105], v[10:11], v[104:105] op_sel:[1,0] op_sel_hi:[1,1]
  v_pk_mul_f32 v[106:107], v[10:11], v[106:107] op_sel:[1,0] op_sel_hi:[1,1]
  v_pk_mul_f32 v[108:109], v[10:11], v[108:109] op_sel:[1,0] op_sel_hi:[1,1]
  v_pk_mul_f32 v[110:111], v[10:11], v[110:111] op_sel:[1,0] op_sel_hi:[1,1]
  s_waitcnt lgkmcnt(8)
  v_pk_fma_f32 v[96:97], v[8:9], v[48:49], v[96:97] op_sel:[0,0,0] op_sel_hi:[0,1,1]
  v_pk_fma_f32 v[98:99], v[8:9], v[50:51], v[98:99] op_sel:[0,0,0] op_sel_hi:[0,1,1]
  v_pk_fma_f32 v[100:101], v[8:9], v[52:53], v[100:101] op_sel:[0,0,0] op_sel_hi:[0,1,1]
  v_pk_fma_f32 v[102:103], v[8:9], v[54:55], v[102:103] op_sel:[0,0,0] op_sel_hi:[0,1,1]
  v_pk_fma_f32 v[104:105], v[8:9], v[56:57], v[104:105] op_sel:[0,0,0] op_sel_hi:[0,1,1]
  v_pk_fma_f32 v[106:107], v[8:9], v[58:59], v[106:107] op_sel:[0,0,0] op_sel_hi:[0,1,1]
  v_pk_fma_f32 v[108:109], v[8:9], v[60:61], v[108:109] op_sel:[0,0,0] op_sel_hi:[0,1,1]
  v_pk_fma_f32 v[110:111], v[8:9], v[62:63], v[110:111] op_sel:[0,0,0] op_sel_hi:[0,1,1]
  s_waitcnt lgkmcnt(4)
  v_pk_fma_f32 v[96:97], v[8:9], v[64:65], v[96:97] op_sel:[1,0,0] op_sel_hi:[1,1,1]
  v_pk_fma_f32 v[98:99], v[8:9], v[66:67], v[98:99] op_sel:[1,0,0] op_sel_hi:[1,1,1]
  v_pk_fma_f32 v[100:101], v[8:9], v[68:69], v[100:101] op_sel:[1,0,0] op_sel_hi:[1,1,1]
  v_pk_fma_f32 v[102:103], v[8:9], v[70:71], v[102:103] op_sel:[1,0,0] op_sel_hi:[1,1,1]
  v_pk_fma_f32 v[104:105], v[8:9], v[72:73], v[104:105] op_sel:[1,0,0] op_sel_hi:[1,1,1]
  v_pk_fma_f32 v[106:107], v[8:9], v[74:75], v[106:107] op_sel:[1,0,0] op_sel_hi:[1,1,1]
  v_pk_fma_f32 v[108:109], v[8:9], v[76:77], v[108:109] op_sel:[1,0,0] op_sel_hi:[1,1,1]
  v_pk_fma_f32 v[110:111], v[8:9], v[78:79], v[110:111] op_sel:[1,0,0] op_sel_hi:[1,1,1]
  s_waitcnt lgkmcnt(0)
  v_pk_fma_f32 v[108:109], v[10:11], v[92:93], v[108:109] op_sel:[0,0,0] op_sel_hi:[0,1,1]
  v_pk_fma_f32 v[96:97], v[10:11], v[80:81], v[96:97] op_sel:[0,0,0] op_sel_hi:[0,1,1]
  v_mov_b32 v12, v108
  v_mov_b32 v13, v108
  v_pk_fma_f32 v[98:99], v[10:11], v[82:83], v[98:99] op_sel:[0,0,0] op_sel_hi:[0,1,1]
  v_pk_fma_f32 v[100:101], v[10:11], v[84:85], v[100:101] op_sel:[0,0,0] op_sel_hi:[0,1,1]
  v_permlane32_swap_b32 v12, v13
  v_pk_fma_f32 v[102:103], v[10:11], v[86:87], v[102:103] op_sel:[0,0,0] op_sel_hi:[0,1,1]
  v_pk_fma_f32 v[104:105], v[10:11], v[88:89], v[104:105] op_sel:[0,0,0] op_sel_hi:[0,1,1]
  v_rcp_f32 v13, v13
  v_pk_fma_f32 v[106:107], v[10:11], v[90:91], v[106:107] op_sel:[0,0,0] op_sel_hi:[0,1,1]
  v_pk_fma_f32 v[110:111], v[10:11], v[94:95], v[110:111] op_sel:[0,0,0] op_sel_hi:[0,1,1]
  v_pk_mul_f32 v[96:97], v[12:13], v[96:97] op_sel:[1,0] op_sel_hi:[1,1]
  v_pk_mul_f32 v[98:99], v[12:13], v[98:99] op_sel:[1,0] op_sel_hi:[1,1]
  v_cvt_pk_bf16_f32 v48, v96, v97
  v_pk_mul_f32 v[100:101], v[12:13], v[100:101] op_sel:[1,0] op_sel_hi:[1,1]
  v_cvt_pk_bf16_f32 v49, v98, v99
  v_pk_mul_f32 v[102:103], v[12:13], v[102:103] op_sel:[1,0] op_sel_hi:[1,1]
  v_cvt_pk_bf16_f32 v50, v100, v101
  v_pk_mul_f32 v[104:105], v[12:13], v[104:105] op_sel:[1,0] op_sel_hi:[1,1]
  v_cvt_pk_bf16_f32 v51, v102, v103
  buffer_store_dwordx4 v[48:51], v1, s[36:39], s15 offen sc1
  v_pk_mul_f32 v[106:107], v[12:13], v[106:107] op_sel:[1,0] op_sel_hi:[1,1]
  v_cvt_pk_bf16_f32 v52, v104, v105
  v_pk_mul_f32 v[108:109], v[12:13], v[108:109] op_sel:[1,0] op_sel_hi:[1,1]
  v_cvt_pk_bf16_f32 v53, v106, v107
  v_pk_mul_f32 v[110:111], v[12:13], v[110:111] op_sel:[1,0] op_sel_hi:[1,1]
  v_cvt_pk_bf16_f32 v54, v108, v109
  v_cvt_pk_bf16_f32 v55, v110, v111
  buffer_store_dwordx4 v[52:55], v1, s[36:39], s15 offen offset:1024 sc1
  v_mov_b32 v8, 100360
  v_mov_b32 v6, 1
  s_mov_b64 exec, 1
  s_waitcnt vmcnt(2)
  ds_add_u32 v8, v6
  s_mov_b64 exec, -1
  s_endpgm
L_k2_slow:
  s_cmp_eq_u32 s14, 1
  s_cbranch_scc1 L_k2_comb
  s_mov_b32 s14, 1
  s_mov_b32 s42, 20971520
  s_mov_b64 exec, s[44:45]
  v_mov_b32 v22, 0
  v_mov_b32 v23, 0
  v_mov_b32 v30, 0
  v_mov_b32 v31, 0
  v_mov_b32 v38, 0
  v_mov_b32 v39, 0
  v_mov_b32 v46, 0
  v_mov_b32 v47, 0
  s_mov_b64 exec, -1
  v_mov_b32 v224, 0xff800000
  v_mov_b32 v225, 0xff800000
  v_mov_b32 v226, 0xff800000
  v_mov_b32 v227, 0xff800000
  s_add_u32 s12, s10, 65536
  s_waitcnt vmcnt(0)
L_k2_slow_loop:
  s_sub_u32 s12, s12, 4096
  buffer_load_dwordx4 v[112:115], v1, s[40:43], s12 offen
  buffer_load_dwordx4 v[116:119], v1, s[40:43], s12 offen offset:1024
  s_waitcnt vmcnt(0)
  v_mfma_f32_32x32x16_bf16 v[176:191], v[112:115], v[16:19], 0
  v_mfma_f32_32x32x16_bf16 v[176:191], v[116:119], v[20:23], v[176:191]
  v_mfma_f32_32x32x16_bf16 v[192:207], v[112:115], v[24:27], 0
  v_mfma_f32_32x32x16_bf16 v[192:207], v[116:119], v[28:31], v[192:207]
  s_nop 9
  v_max3_f32 v224, v224, v176, v177
  v_max3_f32 v224, v224, v178, v179
  v_max3_f32 v224, v224, v180, v181
  v_max3_f32 v224, v224, v182, v183
  v_max3_f32 v224, v224, v184, v185
  v_max3_f32 v224, v224, v186, v187
  v_max3_f32 v224, v224, v188, v189
  v_max3_f32 v224, v224, v190, v191
  v_mfma_f32_32x32x16_bf16 v[176:191], v[112:115], v[32:35], 0
  v_mfma_f32_32x32x16_bf16 v[176:191], v[116:119], v[36:39], v[176:191]
  v_max3_f32 v225, v225, v192, v193
  v_max3_f32 v225, v225, v194, v195
  v_max3_f32 v225, v225, v196, v197
  v_max3_f32 v225, v225, v198, v199
  v_max3_f32 v225, v225, v200, v201
  v_max3_f32 v225, v225, v202, v203
  v_max3_f32 v225, v225, v204, v205
  v_max3_f32 v225, v225, v206, v207
  v_mfma_f32_32x32x16_bf16 v[192:207], v[112:115], v[40:43], 0
  v_mfma_f32_32x32x16_bf16 v[192:207], v[116:119], v[44:47], v[192:207]
  s_nop 1
  v_max3_f32 v226, v226, v176, v177
  v_max3_f32 v226, v226, v178, v179
  v_max3_f32 v226, v226, v180, v181
  v_max3_f32 v226, v226, v182, v183
  v_max3_f32 v226, v226, v184, v185
  v_max3_f32 v226, v226, v186, v187
  v_max3_f32 v226, v226, v188, v189
  v_max3_f32 v226, v226, v190, v191
  s_nop 1
  v_max3_f32 v227, v227, v192, v193
  v_max3_f32 v227, v227, v194, v195
  v_max3_f32 v227, v227, v196, v197
  v_max3_f32 v227, v227, v198, v199
  v_max3_f32 v227, v227, v200, v201
  v_max3_f32 v227, v227, v202, v203
  v_max3_f32 v227, v227, v204, v205
  v_max3_f32 v227, v227, v206, v207
  s_cmp_lg_u32 s12, s10
  s_cbranch_scc1 L_k2_slow_loop
  buffer_load_dwordx4 v[112:115], v1, s[40:43], s12 offen offset:0
  buffer_load_dwordx4 v[116:119], v1, s[40:43], s12 offen offset:1024
  buffer_load_dwordx4 v[120:123], v1, s[40:43], s12 offen offset:2048
  buffer_load_dwordx4 v[124:127], v1, s[40:43], s12 offen offset:3072
  s_add_u32 s12, s12, 4096
  buffer_load_dwordx4 v[128:131], v1, s[40:43], s12 offen offset:0
  buffer_load_dwordx4 v[132:135], v1, s[40:43], s12 offen offset:1024
  buffer_load_dwordx4 v[136:139], v1, s[40:43], s12 offen offset:2048
  buffer_load_dwordx4 v[140:143], v1, s[40:43], s12 offen offset:3072
  s_add_u32 s12, s12, 4096
  buffer_load_dwordx4 v[144:147], v1, s[40:43], s12 offen offset:0
  v_mov_b32 v48, 0
  v_mov_b32 v49, 0
  v_mov_b32 v50, 0
  v_mov_b32 v51, 0
  v_mov_b32 v52, 0
  v_mov_b32 v53, 0
  v_mov_b32 v54, 0
  v_mov_b32 v55, 0
  v_mov_b32 v56, 0
  v_mov_b32 v57, 0
  v_mov_b32 v58, 0
  v_mov_b32 v59, 0
  v_mov_b32 v60, 0
  v_mov_b32 v61, 0
  v_mov_b32 v62, 0
  v_mov_b32 v63, 0
  v_mov_b32 v64, 0
  v_mov_b32 v65, 0
  v_mov_b32 v66, 0
  v_mov_b32 v67, 0
  v_mov_b32 v68, 0
  v_mov_b32 v69, 0
  v_mov_b32 v70, 0
  v_mov_b32 v71, 0
  v_mov_b32 v72, 0
  v_mov_b32 v73, 0
  v_mov_b32 v74, 0
  v_mov_b32 v75, 0
  v_mov_b32 v76, 0
  v_mov_b32 v77, 0
  v_mov_b32 v78, 0
  v_mov_b32 v79, 0
  v_mov_b32 v80, 0
  v_mov_b32 v81, 0
  v_mov_b32 v82, 0
  v_mov_b32 v83, 0
  v_mov_b32 v84, 0
  v_mov_b32 v85, 0
  v_mov_b32 v86, 0
  v_mov_b32 v87, 0
  v_mov_b32 v88, 0
  v_mov_b32 v89, 0
  v_mov_b32 v90, 0
  v_mov_b32 v91, 0
  v_mov_b32 v92, 0
  v_mov_b32 v93, 0
  v_mov_b32 v94, 0
  v_mov_b32 v95, 0
  v_mov_b32 v96, 0
  v_mov_b32 v97, 0
  v_mov_b32 v98, 0
  v_mov_b32 v99, 0
  v_mov_b32 v100, 0
  v_mov_b32 v101, 0
  v_mov_b32 v102, 0
  v_mov_b32 v103, 0
  v_mov_b32 v104, 0
  v_mov_b32 v105, 0
  v_mov_b32 v106, 0
  v_mov_b32 v107, 0
  v_mov_b32 v108, 0
  v_mov_b32 v109, 0
  v_mov_b32 v110, 0
  v_mov_b32 v111, 0
  s_waitcnt vmcnt(0)
  s_branch L_k2_main
L_k2_gemm:
  s_load_dwordx2 s[48:49], s[0:1], 0
  s_load_dwordx2 s[52:53], s[0:1], 56
  s_sub_u32 s3, s3, 4
  s_mul_i32 s6, s5, 9363
  s_lshr_b32 s6, s6, 16
  s_mul_i32 s7, s6, 7
  s_sub_u32 s7, s5, s7
  s_lshl_b32 s8, s4, 3
  s_lshl_b32 s9, s6, 1
  s_add_u32 s8, s8, s9
  s_and_b32 s12, s3, 1
  s_lshr_b32 s13, s3, 1
  s_add_u32 s8, s8, s12
  s_lshl_b32 s7, s7, 1
  s_add_u32 s7, s7, s13
  s_mul_i32 s10, s3, 28672
  s_mul_i32 s11, s8, 114688
  s_add_u32 s11, s11, s10
  s_add_u32 s18, s11, 6291456
  s_xor_b32 s9, s8, 1
  s_mul_i32 s11, s9, 114688
  s_add_u32 s11, s11, s10
  s_add_u32 s16, s11, 6291456
  s_mul_i32 s11, s7, 114688
  s_add_u32 s11, s11, s10
  s_add_u32 s19, s11, 13631488
  s_xor_b32 s9, s7, 1
  s_mul_i32 s11, s9, 114688
  s_add_u32 s11, s11, s10
  s_add_u32 s17, s11, 13631488
  s_waitcnt lgkmcnt(0)
  s_barrier
  s_cmp_ge_u32 s5, 28
  s_cbranch_scc1 L_k2_exit
  s_and_b32 s24, s7, -2
  s_add_u32 s24, s24, s12
  s_lshl_b32 s24, s24, 15
  s_lshl_b32 s9, s13, 14
  s_add_u32 s24, s24, s9
  s_add_u32 s24, s24, 15729664
  s_mul_i32 s30, s13, 30720
  s_mul_i32 s9, s12, 15360
  s_add_u32 s30, s30, s9
  s_add_u32 s30, s30, 100608
  buffer_load_dwordx4 v[80:83], v1, s[36:39], s16 offen offset:0
  buffer_load_dwordx4 v[84:87], v1, s[36:39], s17 offen offset:0
  buffer_load_dwordx4 v[88:91], v1, s[36:39], s18 offen offset:0
  buffer_load_dwordx4 v[92:95], v1, s[36:39], s19 offen offset:0
  buffer_load_dwordx4 v[96:99], v1, s[36:39], s16 offen offset:1024
  buffer_load_dwordx4 v[100:103], v1, s[36:39], s17 offen offset:1024
  buffer_load_dwordx4 v[104:107], v1, s[36:39], s18 offen offset:1024
  buffer_load_dwordx4 v[108:111], v1, s[36:39], s19 offen offset:1024
  s_mul_i32 s10, s3, 12288
  s_add_u32 s10, s10, 49152
  v_add_u32 v6, s10, v1
  s_xor_b32 s15, s3, 3
  s_mul_i32 s20, s15, 12288
  s_add_u32 s20, s20, 49152
  v_add_u32 v8, s20, v1
  s_xor_b32 s15, s3, 2
  s_mul_i32 s20, s15, 12288
  s_add_u32 s20, s20, 53248
  v_add_u32 v9, s20, v1
  s_xor_b32 s15, s3, 1
  s_mul_i32 s20, s15, 12288
  s_add_u32 s20, s20, 57344
  v_add_u32 v10, s20, v1
  v_mov_b32 v4, 100352
  v_mov_b32 v5, 1
  s_mul_i32 s10, s8, 14
  s_add_u32 s10, s10, s7
  s_lshl_b32 s10, s10, 11
  s_add_u32 s10, s10, 18874368
  s_waitcnt vmcnt(6)
  v_mfma_f32_32x32x16_bf16 v[16:31], v[84:87], v[80:83], 0
  buffer_load_dwordx4 v[112:115], v1, s[36:39], s16 offen offset:2048
  s_waitcnt vmcnt(6)
  v_mfma_f32_32x32x16_bf16 v[32:47], v[84:87], v[88:91], 0
  buffer_load_dwordx4 v[116:119], v1, s[36:39], s17 offen offset:2048
  s_waitcnt vmcnt(6)
  v_mfma_f32_32x32x16_bf16 v[48:63], v[92:95], v[80:83], 0
  buffer_load_dwordx4 v[120:123], v1, s[36:39], s18 offen offset:2048
  v_mfma_f32_32x32x16_bf16 v[64:79], v[92:95], v[88:91], 0
  buffer_load_dwordx4 v[124:127], v1, s[36:39], s19 offen offset:2048
  s_waitcnt vmcnt(6)
  v_mfma_f32_32x32x16_bf16 v[16:31], v[100:103], v[96:99], v[16:31]
  buffer_load_dwordx4 v[128:131], v1, s[36:39], s16 offen offset:3072
  s_add_u32 s16, s16, 4096
  s_add_u32 m0, s30, 0
  s_add_u32 s25, s24, 0
  buffer_load_dwordx4 v1, s[36:39], s25 offen offset:0 lds
  s_waitcnt vmcnt(7)
  v_mfma_f32_32x32x16_bf16 v[32:47], v[100:103], v[104:107], v[32:47]
  buffer_load_dwordx4 v[132:135], v1, s[36:39], s17 offen offset:3072
  s_add_u32 s17, s17, 4096
  s_waitcnt vmcnt(7)
  v_mfma_f32_32x32x16_bf16 v[48:63], v[108:111], v[96:99], v[48:63]
  buffer_load_dwordx4 v[136:139], v1, s[36:39], s18 offen offset:3072
  s_add_u32 s18, s18, 4096
  v_mfma_f32_32x32x16_bf16 v[64:79], v[108:111], v[104:107], v[64:79]
  buffer_load_dwordx4 v[140:143], v1, s[36:39], s19 offen offset:3072
  s_add_u32 s19, s19, 4096
  s_waitcnt vmcnt(7)
  v_mfma_f32_32x32x16_bf16 v[16:31], v[116:119], v[112:115], v[16:31]
  buffer_load_dwordx4 v[144:147], v1, s[36:39], s16 offen offset:0
  s_waitcnt vmcnt(7)
  v_mfma_f32_32x32x16_bf16 v[32:47], v[116:119], v[120:123], v[32:47]
  buffer_load_dwordx4 v[148:151], v1, s[36:39], s17 offen offset:0
  s_waitcnt vmcnt(7)
  v_mfma_f32_32x32x16_bf16 v[48:63], v[124:127], v[112:115], v[48:63]
  buffer_load_dwordx4 v[152:155], v1, s[36:39], s18 offen offset:0
  buffer_load_dwordx4 v1, s[36:39], s25 offen offset:1024 lds
  v_mfma_f32_32x32x16_bf16 v[64:79], v[124:127], v[120:123], v[64:79]
  buffer_load_dwordx4 v[156:159], v1, s[36:39], s19 offen offset:0
  s_waitcnt vmcnt(7)
  v_mfma_f32_32x32x16_bf16 v[16:31], v[132:135], v[128:131], v[16:31]
  buffer_load_dwordx4 v[160:163], v1, s[36:39], s16 offen offset:1024
  s_waitcnt vmcnt(7)
  v_mfma_f32_32x32x16_bf16 v[32:47], v[132:135], v[136:139], v[32:47]
  buffer_load_dwordx4 v[164:167], v1, s[36:39], s17 offen offset:1024
  s_waitcnt vmcnt(7)
  v_mfma_f32_32x32x16_bf16 v[48:63], v[140:143], v[128:131], v[48:63]
  buffer_load_dwordx4 v[168:171], v1, s[36:39], s18 offen offset:1024
  v_mfma_f32_32x32x16_bf16 v[64:79], v[140:143], v[136:139], v[64:79]
  buffer_load_dwordx4 v[172:175], v1, s[36:39], s19 offen offset:1024
  s_waitcnt vmcnt(7)
  v_mfma_f32_32x32x16_bf16 v[16:31], v[148:151], v[144:147], v[16:31]
  buffer_load_dwordx4 v[176:179], v1, s[36:39], s16 offen offset:2048
  buffer_load_dwordx4 v1, s[36:39], s25 offen offset:2048 lds
  s_waitcnt vmcnt(8)
  v_mfma_f32_32x32x16_bf16 v[32:47], v[148:151], v[152:155], v[32:47]
  buffer_load_dwordx4 v[180:183], v1, s[36:39], s17 offen offset:2048
  s_waitcnt vmcnt(7)
  v_mfma_f32_32x32x16_bf16 v[48:63], v[156:159], v[144:147], v[48:63]
  buffer_load_dwordx4 v[184:187], v1, s[36:39], s18 offen offset:2048
  v_mfma_f32_32x32x16_bf16 v[64:79], v[156:159], v[152:155], v[64:79]
  buffer_load_dwordx4 v[188:191], v1, s[36:39], s19 offen offset:2048
  s_waitcnt vmcnt(7)
  v_mfma_f32_32x32x16_bf16 v[16:31], v[164:167], v[160:163], v[16:31]
  buffer_load_dwordx4 v[192:195], v1, s[36:39], s16 offen offset:3072
  s_add_u32 s16, s16, 4096
  s_waitcnt vmcnt(7)
  v_mfma_f32_32x32x16_bf16 v[32:47], v[164:167], v[168:171], v[32:47]
  buffer_load_dwordx4 v[196:199], v1, s[36:39], s17 offen offset:3072
  s_add_u32 s17, s17, 4096
  s_waitcnt vmcnt(7)
  v_mfma_f32_32x32x16_bf16 v[48:63], v[172:175], v[160:163], v[48:63]
  buffer_load_dwordx4 v[200:203], v1, s[36:39], s18 offen offset:3072
  s_add_u32 s18, s18, 4096
  buffer_load_dwordx4 v1, s[36:39], s25 offen offset:3072 lds
  v_mfma_f32_32x32x16_bf16 v[64:79], v[172:175], v[168:171], v[64:79]
  buffer_load_dwordx4 v[204:207], v1, s[36:39], s19 offen offset:3072
  s_add_u32 s19, s19, 4096
  s_waitcnt vmcnt(7)
  v_mfma_f32_32x32x16_bf16 v[16:31], v[180:183], v[176:179], v[16:31]
  buffer_load_dwordx4 v[208:211], v1, s[36:39], s16 offen offset:0
  s_waitcnt vmcnt(7)
  v_mfma_f32_32x32x16_bf16 v[32:47], v[180:183], v[184:187], v[32:47]
  buffer_load_dwordx4 v[212:215], v1, s[36:39], s17 offen offset:0
  s_waitcnt vmcnt(7)
  v_mfma_f32_32x32x16_bf16 v[48:63], v[188:191], v[176:179], v[48:63]
  buffer_load_dwordx4 v[216:219], v1, s[36:39], s18 offen offset:0
  v_mfma_f32_32x32x16_bf16 v[64:79], v[188:191], v[184:187], v[64:79]
  buffer_load_dwordx4 v[220:223], v1, s[36:39], s19 offen offset:0
  s_waitcnt vmcnt(7)
  v_mfma_f32_32x32x16_bf16 v[16:31], v[196:199], v[192:195], v[16:31]
  buffer_load_dwordx4 v[224:227], v1, s[36:39], s16 offen offset:1024
  s_add_u32 m0, s30, 4096
  s_add_u32 s25, s24, 4096
  buffer_load_dwordx4 v1, s[36:39], s25 offen offset:0 lds
  s_waitcnt vmcnt(8)
  v_mfma_f32_32x32x16_bf16 v[32:47], v[196:199], v[200:203], v[32:47]
  buffer_load_dwordx4 v[228:231], v1, s[36:39], s17 offen offset:1024
  s_waitcnt vmcnt(7)
  v_mfma_f32_32x32x16_bf16 v[48:63], v[204:207], v[192:195], v[48:63]
  buffer_load_dwordx4 v[232:235], v1, s[36:39], s18 offen offset:1024
  v_mfma_f32_32x32x16_bf16 v[64:79], v[204:207], v[200:203], v[64:79]
  buffer_load_dwordx4 v[236:239], v1, s[36:39], s19 offen offset:1024
  s_waitcnt vmcnt(7)
  v_mfma_f32_32x32x16_bf16 v[16:31], v[212:215], v[208:211], v[16:31]
  buffer_load_dwordx4 v[80:83], v1, s[36:39], s16 offen offset:2048
  s_waitcnt vmcnt(7)
  v_mfma_f32_32x32x16_bf16 v[32:47], v[212:215], v[216:219], v[32:47]
  buffer_load_dwordx4 v[84:87], v1, s[36:39], s17 offen offset:2048
  s_waitcnt vmcnt(7)
  v_mfma_f32_32x32x16_bf16 v[48:63], v[220:223], v[208:211], v[48:63]
  buffer_load_dwordx4 v[88:91], v1, s[36:39], s18 offen offset:2048
  buffer_load_dwordx4 v1, s[36:39], s25 offen offset:1024 lds
  v_mfma_f32_32x32x16_bf16 v[64:79], v[220:223], v[216:219], v[64:79]
  buffer_load_dwordx4 v[92:95], v1, s[36:39], s19 offen offset:2048
  s_waitcnt vmcnt(7)
  v_mfma_f32_32x32x16_bf16 v[16:31], v[228:231], v[224:227], v[16:31]
  buffer_load_dwordx4 v[96:99], v1, s[36:39], s16 offen offset:3072
  s_add_u32 s16, s16, 4096
  s_waitcnt vmcnt(7)
  v_mfma_f32_32x32x16_bf16 v[32:47], v[228:231], v[232:235], v[32:47]
  buffer_load_dwordx4 v[100:103], v1, s[36:39], s17 offen offset:3072
  s_add_u32 s17, s17, 4096
  s_waitcnt vmcnt(7)
  v_mfma_f32_32x32x16_bf16 v[48:63], v[236:239], v[224:227], v[48:63]
  buffer_load_dwordx4 v[104:107], v1, s[36:39], s18 offen offset:3072
  s_add_u32 s18, s18, 4096
  v_mfma_f32_32x32x16_bf16 v[64:79], v[236:239], v[232:235], v[64:79]
  buffer_load_dwordx4 v[108:111], v1, s[36:39], s19 offen offset:3072
  s_add_u32 s19, s19, 4096
  s_waitcnt vmcnt(7)
  v_mfma_f32_32x32x16_bf16 v[16:31], v[84:87], v[80:83], v[16:31]
  buffer_load_dwordx4 v[112:115], v1, s[36:39], s16 offen offset:0
  buffer_load_dwordx4 v1, s[36:39], s25 offen offset:2048 lds
  s_waitcnt vmcnt(8)
  v_mfma_f32_32x32x16_bf16 v[32:47], v[84:87], v[88:91], v[32:47]
  buffer_load_dwordx4 v[116:119], v1, s[36:39], s17 offen offset:0
  s_waitcnt vmcnt(7)
  v_mfma_f32_32x32x16_bf16 v[48:63], v[92:95], v[80:83], v[48:63]
  buffer_load_dwordx4 v[120:123], v1, s[36:39], s18 offen offset:0
  v_mfma_f32_32x32x16_bf16 v[64:79], v[92:95], v[88:91], v[64:79]
  buffer_load_dwordx4 v[124:127], v1, s[36:39], s19 offen offset:0
  s_waitcnt vmcnt(7)
  v_mfma_f32_32x32x16_bf16 v[16:31], v[100:103], v[96:99], v[16:31]
  buffer_load_dwordx4 v[128:131], v1, s[36:39], s16 offen offset:1024
  s_waitcnt vmcnt(7)
  v_mfma_f32_32x32x16_bf16 v[32:47], v[100:103], v[104:107], v[32:47]
  buffer_load_dwordx4 v[132:135], v1, s[36:39], s17 offen offset:1024
  s_waitcnt vmcnt(7)
  v_mfma_f32_32x32x16_bf16 v[48:63], v[108:111], v[96:99], v[48:63]
  buffer_load_dwordx4 v[136:139], v1, s[36:39], s18 offen offset:1024
  buffer_load_dwordx4 v1, s[36:39], s25 offen offset:3072 lds
  v_mfma_f32_32x32x16_bf16 v[64:79], v[108:111], v[104:107], v[64:79]
  buffer_load_dwordx4 v[140:143], v1, s[36:39], s19 offen offset:1024
  s_waitcnt vmcnt(7)
  v_mfma_f32_32x32x16_bf16 v[16:31], v[116:119], v[112:115], v[16:31]
  buffer_load_dwordx4 v[144:147], v1, s[36:39], s16 offen offset:2048
  s_waitcnt vmcnt(7)
  v_mfma_f32_32x32x16_bf16 v[32:47], v[116:119], v[120:123], v[32:47]
  buffer_load_dwordx4 v[148:151], v1, s[36:39], s17 offen offset:2048
  s_waitcnt vmcnt(7)
  v_mfma_f32_32x32x16_bf16 v[48:63], v[124:127], v[112:115], v[48:63]
  buffer_load_dwordx4 v[152:155], v1, s[36:39], s18 offen offset:2048
  v_mfma_f32_32x32x16_bf16 v[64:79], v[124:127], v[120:123], v[64:79]
  buffer_load_dwordx4 v[156:159], v1, s[36:39], s19 offen offset:2048
  s_waitcnt vmcnt(7)
  v_mfma_f32_32x32x16_bf16 v[16:31], v[132:135], v[128:131], v[16:31]
  buffer_load_dwordx4 v[160:163], v1, s[36:39], s16 offen offset:3072
  s_add_u32 s16, s16, 4096
  s_add_u32 m0, s30, 8192
  s_add_u32 s25, s24, 8192
  buffer_load_dwordx4 v1, s[36:39], s25 offen offset:0 lds
  s_waitcnt vmcnt(8)
  v_mfma_f32_32x32x16_bf16 v[32:47], v[132:135], v[136:139], v[32:47]
  buffer_load_dwordx4 v[164:167], v1, s[36:39], s17 offen offset:3072
  s_add_u32 s17, s17, 4096
  s_waitcnt vmcnt(7)
  v_mfma_f32_32x32x16_bf16 v[48:63], v[140:143], v[128:131], v[48:63]
  buffer_load_dwordx4 v[168:171], v1, s[36:39], s18 offen offset:3072
  s_add_u32 s18, s18, 4096
  v_mfma_f32_32x32x16_bf16 v[64:79], v[140:143], v[136:139], v[64:79]
  buffer_load_dwordx4 v[172:175], v1, s[36:39], s19 offen offset:3072
  s_add_u32 s19, s19, 4096
  s_waitcnt vmcnt(7)
  v_mfma_f32_32x32x16_bf16 v[16:31], v[148:151], v[144:147], v[16:31]
  buffer_load_dwordx4 v[176:179], v1, s[36:39], s16 offen offset:0
  s_waitcnt vmcnt(7)
  v_mfma_f32_32x32x16_bf16 v[32:47], v[148:151], v[152:155], v[32:47]
  buffer_load_dwordx4 v[180:183], v1, s[36:39], s17 offen offset:0
  s_waitcnt vmcnt(7)
  v_mfma_f32_32x32x16_bf16 v[48:63], v[156:159], v[144:147], v[48:63]
  buffer_load_dwordx4 v[184:187], v1, s[36:39], s18 offen offset:0
  buffer_load_dwordx4 v1, s[36:39], s25 offen offset:1024 lds
  v_mfma_f32_32x32x16_bf16 v[64:79], v[156:159], v[152:155], v[64:79]
  buffer_load_dwordx4 v[188:191], v1, s[36:39], s19 offen offset:0
  s_waitcnt vmcnt(7)
  v_mfma_f32_32x32x16_bf16 v[16:31], v[164:167], v[160:163], v[16:31]
  buffer_load_dwordx4 v[192:195], v1, s[36:39], s16 offen offset:1024
  s_waitcnt vmcnt(7)
  v_mfma_f32_32x32x16_bf16 v[32:47], v[164:167], v[168:171], v[32:47]
  buffer_load_dwordx4 v[196:199], v1, s[36:39], s17 offen offset:1024
  s_waitcnt vmcnt(7)
  v_mfma_f32_32x32x16_bf16 v[48:63], v[172:175], v[160:163], v[48:63]
  buffer_load_dwordx4 v[200:203], v1, s[36:39], s18 offen offset:1024
  v_mfma_f32_32x32x16_bf16 v[64:79], v[172:175], v[168:171], v[64:79]
  buffer_load_dwordx4 v[204:207], v1, s[36:39], s19 offen offset:1024
  s_waitcnt vmcnt(7)
  v_mfma_f32_32x32x16_bf16 v[16:31], v[180:183], v[176:179], v[16:31]
  buffer_load_dwordx4 v[208:211], v1, s[36:39], s16 offen offset:2048
  buffer_load_dwordx4 v1, s[36:39], s25 offen offset:2048 lds
  s_waitcnt vmcnt(8)
  v_mfma_f32_32x32x16_bf16 v[32:47], v[180:183], v[184:187], v[32:47]
  buffer_load_dwordx4 v[212:215], v1, s[36:39], s17 offen offset:2048
  s_waitcnt vmcnt(7)
  v_mfma_f32_32x32x16_bf16 v[48:63], v[188:191], v[176:179], v[48:63]
  buffer_load_dwordx4 v[216:219], v1, s[36:39], s18 offen offset:2048
  v_mfma_f32_32x32x16_bf16 v[64:79], v[188:191], v[184:187], v[64:79]
  buffer_load_dwordx4 v[220:223], v1, s[36:39], s19 offen offset:2048
  s_waitcnt vmcnt(7)
  v_mfma_f32_32x32x16_bf16 v[16:31], v[196:199], v[192:195], v[16:31]
  buffer_load_dwordx4 v[224:227], v1, s[36:39], s16 offen offset:3072
  s_add_u32 s16, s16, 4096
  s_waitcnt vmcnt(7)
  v_mfma_f32_32x32x16_bf16 v[32:47], v[196:199], v[200:203], v[32:47]
  buffer_load_dwordx4 v[228:231], v1, s[36:39], s17 offen offset:3072
  s_add_u32 s17, s17, 4096
  s_waitcnt vmcnt(7)
  v_mfma_f32_32x32x16_bf16 v[48:63], v[204:207], v[192:195], v[48:63]
  buffer_load_dwordx4 v[232:235], v1, s[36:39], s18 offen offset:3072
  s_add_u32 s18, s18, 4096
  buffer_load_dwordx4 v1, s[36:39], s25 offen offset:3072 lds
  v_mfma_f32_32x32x16_bf16 v[64:79], v[204:207], v[200:203], v[64:79]
  buffer_load_dwordx4 v[236:239], v1, s[36:39], s19 offen offset:3072
  s_add_u32 s19, s19, 4096
  s_waitcnt vmcnt(7)
  v_mfma_f32_32x32x16_bf16 v[16:31], v[212:215], v[208:211], v[16:31]
  buffer_load_dwordx4 v[80:83], v1, s[36:39], s16 offen offset:0
  s_waitcnt vmcnt(7)
  v_mfma_f32_32x32x16_bf16 v[32:47], v[212:215], v[216:219], v[32:47]
  buffer_load_dwordx4 v[84:87], v1, s[36:39], s17 offen offset:0
  s_waitcnt vmcnt(7)
  v_mfma_f32_32x32x16_bf16 v[48:63], v[220:223], v[208:211], v[48:63]
  buffer_load_dwordx4 v[88:91], v1, s[36:39], s18 offen offset:0
  v_mfma_f32_32x32x16_bf16 v[64:79], v[220:223], v[216:219], v[64:79]
  buffer_load_dwordx4 v[92:95], v1, s[36:39], s19 offen offset:0
  s_waitcnt vmcnt(7)
  v_mfma_f32_32x32x16_bf16 v[16:31], v[228:231], v[224:227], v[16:31]
  buffer_load_dwordx4 v[96:99], v1, s[36:39], s16 offen offset:1024
  s_add_u32 m0, s30, 12288
  s_add_u32 s25, s24, 12288
  buffer_load_dwordx4 v1, s[36:39], s25 offen offset:0 lds
  s_waitcnt vmcnt(8)
  v_mfma_f32_32x32x16_bf16 v[32:47], v[228:231], v[232:235], v[32:47]
  buffer_load_dwordx4 v[100:103], v1, s[36:39], s17 offen offset:1024
  s_waitcnt vmcnt(7)
  v_mfma_f32_32x32x16_bf16 v[48:63], v[236:239], v[224:227], v[48:63]
  buffer_load_dwordx4 v[104:107], v1, s[36:39], s18 offen offset:1024
  v_mfma_f32_32x32x16_bf16 v[64:79], v[236:239], v[232:235], v[64:79]
  buffer_load_dwordx4 v[108:111], v1, s[36:39], s19 offen offset:1024
  s_waitcnt vmcnt(7)
  v_mfma_f32_32x32x16_bf16 v[16:31], v[84:87], v[80:83], v[16:31]
  buffer_load_dwordx4 v[112:115], v1, s[36:39], s16 offen offset:2048
  s_waitcnt vmcnt(7)
  v_mfma_f32_32x32x16_bf16 v[32:47], v[84:87], v[88:91], v[32:47]
  buffer_load_dwordx4 v[116:119], v1, s[36:39], s17 offen offset:2048
  s_waitcnt vmcnt(7)
  v_mfma_f32_32x32x16_bf16 v[48:63], v[92:95], v[80:83], v[48:63]
  buffer_load_dwordx4 v[120:123], v1, s[36:39], s18 offen offset:2048
  buffer_load_dwordx4 v1, s[36:39], s25 offen offset:1024 lds
  v_mfma_f32_32x32x16_bf16 v[64:79], v[92:95], v[88:91], v[64:79]
  buffer_load_dwordx4 v[124:127], v1, s[36:39], s19 offen offset:2048
  s_waitcnt vmcnt(7)
  v_mfma_f32_32x32x16_bf16 v[16:31], v[100:103], v[96:99], v[16:31]
  buffer_load_dwordx4 v[128:131], v1, s[36:39], s16 offen offset:3072
  s_add_u32 s16, s16, 4096
  s_waitcnt vmcnt(7)
  v_mfma_f32_32x32x16_bf16 v[32:47], v[100:103], v[104:107], v[32:47]
  buffer_load_dwordx4 v[132:135], v1, s[36:39], s17 offen offset:3072
  s_add_u32 s17, s17, 4096
  s_waitcnt vmcnt(7)
  v_mfma_f32_32x32x16_bf16 v[48:63], v[108:111], v[96:99], v[48:63]
  buffer_load_dwordx4 v[136:139], v1, s[36:39], s18 offen offset:3072
  s_add_u32 s18, s18, 4096
  v_mfma_f32_32x32x16_bf16 v[64:79], v[108:111], v[104:107], v[64:79]
  buffer_load_dwordx4 v[140:143], v1, s[36:39], s19 offen offset:3072
  s_add_u32 s19, s19, 4096
  s_waitcnt vmcnt(7)
  v_mfma_f32_32x32x16_bf16 v[16:31], v[116:119], v[112:115], v[16:31]
  buffer_load_dwordx4 v[144:147], v1, s[36:39], s16 offen offset:0
  buffer_load_dwordx4 v1, s[36:39], s25 offen offset:2048 lds
  s_waitcnt vmcnt(8)
  v_mfma_f32_32x32x16_bf16 v[32:47], v[116:119], v[120:123], v[32:47]
  buffer_load_dwordx4 v[148:151], v1, s[36:39], s17 offen offset:0
  s_waitcnt vmcnt(7)
  v_mfma_f32_32x32x16_bf16 v[48:63], v[124:127], v[112:115], v[48:63]
  buffer_load_dwordx4 v[152:155], v1, s[36:39], s18 offen offset:0
  v_mfma_f32_32x32x16_bf16 v[64:79], v[124:127], v[120:123], v[64:79]
  buffer_load_dwordx4 v[156:159], v1, s[36:39], s19 offen offset:0
  s_waitcnt vmcnt(7)
  v_mfma_f32_32x32x16_bf16 v[16:31], v[132:135], v[128:131], v[16:31]
  buffer_load_dwordx4 v[160:163], v1, s[36:39], s16 offen offset:1024
  s_waitcnt vmcnt(7)
  v_mfma_f32_32x32x16_bf16 v[32:47], v[132:135], v[136:139], v[32:47]
  buffer_load_dwordx4 v[164:167], v1, s[36:39], s17 offen offset:1024
  s_waitcnt vmcnt(7)
  v_mfma_f32_32x32x16_bf16 v[48:63], v[140:143], v[128:131], v[48:63]
  buffer_load_dwordx4 v[168:171], v1, s[36:39], s18 offen offset:1024
  v_mfma_f32_32x32x16_bf16 v[64:79], v[140:143], v[136:139], v[64:79]
  buffer_load_dwordx4 v[172:175], v1, s[36:39], s19 offen offset:1024
  s_waitcnt vmcnt(6)
  v_mfma_f32_32x32x16_bf16 v[16:31], v[148:151], v[144:147], v[16:31]
  buffer_load_dwordx4 v[176:179], v1, s[36:39], s16 offen offset:2048
  s_waitcnt vmcnt(6)
  v_mfma_f32_32x32x16_bf16 v[32:47], v[148:151], v[152:155], v[32:47]
  buffer_load_dwordx4 v[180:183], v1, s[36:39], s17 offen offset:2048
  s_waitcnt vmcnt(6)
  v_mfma_f32_32x32x16_bf16 v[48:63], v[156:159], v[144:147], v[48:63]
  buffer_load_dwordx4 v[184:187], v1, s[36:39], s18 offen offset:2048
  v_mfma_f32_32x32x16_bf16 v[64:79], v[156:159], v[152:155], v[64:79]
  buffer_load_dwordx4 v[188:191], v1, s[36:39], s19 offen offset:2048
  s_waitcnt vmcnt(6)
  v_mfma_f32_32x32x16_bf16 v[16:31], v[164:167], v[160:163], v[16:31]
  buffer_load_dwordx4 v[192:195], v1, s[36:39], s16 offen offset:3072
  s_add_u32 s16, s16, 4096
  s_waitcnt vmcnt(6)
  v_mfma_f32_32x32x16_bf16 v[32:47], v[164:167], v[168:171], v[32:47]
  buffer_load_dwordx4 v[196:199], v1, s[36:39], s17 offen offset:3072
  s_add_u32 s17, s17, 4096
  s_waitcnt vmcnt(6)
  v_mfma_f32_32x32x16_bf16 v[48:63], v[172:175], v[160:163], v[48:63]
  buffer_load_dwordx4 v[200:203], v1, s[36:39], s18 offen offset:3072
  s_add_u32 s18, s18, 4096
  v_mfma_f32_32x32x16_bf16 v[64:79], v[172:175], v[168:171], v[64:79]
  buffer_load_dwordx4 v[204:207], v1, s[36:39], s19 offen offset:3072
  s_add_u32 s19, s19, 4096
  s_waitcnt vmcnt(6)
  v_mfma_f32_32x32x16_bf16 v[16:31], v[180:183], v[176:179], v[16:31]
  s_waitcnt vmcnt(5)
  v_mfma_f32_32x32x16_bf16 v[32:47], v[180:183], v[184:187], v[32:47]
  s_waitcnt vmcnt(4)
  v_mfma_f32_32x32x16_bf16 v[48:63], v[188:191], v[176:179], v[48:63]
  v_mfma_f32_32x32x16_bf16 v[64:79], v[188:191], v[184:187], v[64:79]
  s_waitcnt vmcnt(2)
  v_mfma_f32_32x32x16_bf16 v[16:31], v[196:199], v[192:195], v[16:31]
  s_waitcnt vmcnt(1)
  v_mfma_f32_32x32x16_bf16 v[32:47], v[196:199], v[200:203], v[32:47]
  s_waitcnt vmcnt(0)
  v_mfma_f32_32x32x16_bf16 v[48:63], v[204:207], v[192:195], v[48:63]
  v_mfma_f32_32x32x16_bf16 v[64:79], v[204:207], v[200:203], v[64:79]
  s_mov_b32 s38, 20971520
  s_nop 5
  ds_write_b128 v8, v[16:19] offset:0
  ds_write_b128 v8, v[20:23] offset:1024
  ds_write_b128 v8, v[24:27] offset:2048
  ds_write_b128 v8, v[28:31] offset:3072
  ds_write_b128 v9, v[32:35] offset:0
  ds_write_b128 v9, v[36:39] offset:1024
  ds_write_b128 v9, v[40:43] offset:2048
  ds_write_b128 v9, v[44:47] offset:3072
  ds_write_b128 v10, v[48:51] offset:0
  ds_write_b128 v10, v[52:55] offset:1024
  ds_write_b128 v10, v[56:59] offset:2048
  ds_write_b128 v10, v[60:63] offset:3072
  s_waitcnt lgkmcnt(0)
  s_mov_b64 exec, 1
  ds_add_u32 v4, v5
  s_mov_b64 exec, -1
  s_lshl_b32 s9, s13, 14
  s_lshl_b32 s11, s7, 15
  s_add_u32 s11, s11, s9
  s_add_u32 s20, s11, 15728640
  s_xor_b32 s21, s20, 32768
  buffer_load_dwordx4 v[80:83], v1, s[36:39], s20 offen
  buffer_load_dwordx4 v[84:87], v1, s[36:39], s21 offen
  s_lshl_b32 s11, s8, 15
  s_add_u32 s11, s11, s9
  s_add_u32 s24, s11, 16777216
  s_add_u32 s25, s24, 4096
  s_add_u32 s26, s24, 8192
  s_add_u32 s27, s24, 12288
  v_and_b32 v2, 31, v0
  v_lshrrev_b32 v3, 5, v0
  v_mul_u32_u24 v7, 896, v2
  v_lshl_add_u32 v7, v3, 4, v7
  s_mul_i32 s56, s8, 28672
  s_lshl_b32 s11, s7, 6
  s_add_u32 s56, s56, s11
  s_mov_b32 s50, 1835008
  s_mov_b32 s51, 0x00020000
  s_mov_b32 s54, 1835008
  s_mov_b32 s55, 0x00020000
  s_mov_b32 s57, 0
  buffer_load_dwordx4 v[8:11], v7, s[48:51], s56 offen
  buffer_load_dwordx4 v[12:15], v7, s[48:51], s56 offen offset:32
L_k2_poll:
  ds_read_b32 v5, v4
  s_waitcnt lgkmcnt(0)
  v_readfirstlane_b32 s11, v5
  s_cmp_ge_u32 s11, 4
  s_cbranch_scc1 L_k2_red
  s_sleep 1
  s_branch L_k2_poll
L_k2_red:
  ds_read_b128 v[16:19], v6 offset:0
  ds_read_b128 v[20:23], v6 offset:1024
  ds_read_b128 v[24:27], v6 offset:2048
  ds_read_b128 v[28:31], v6 offset:3072
  ds_read_b128 v[32:35], v6 offset:4096
  ds_read_b128 v[36:39], v6 offset:5120
  ds_read_b128 v[40:43], v6 offset:6144
  ds_read_b128 v[44:47], v6 offset:7168
  ds_read_b128 v[48:51], v6 offset:8192
  ds_read_b128 v[52:55], v6 offset:9216
  ds_read_b128 v[56:59], v6 offset:10240
  ds_read_b128 v[60:63], v6 offset:11264
  s_waitcnt lgkmcnt(8)
  v_pk_add_f32 v[64:65], v[64:65], v[16:17]
  v_pk_add_f32 v[66:67], v[66:67], v[18:19]
  v_pk_add_f32 v[68:69], v[68:69], v[20:21]
  v_pk_add_f32 v[70:71], v[70:71], v[22:23]
  v_pk_add_f32 v[72:73], v[72:73], v[24:25]
  v_pk_add_f32 v[74:75], v[74:75], v[26:27]
  v_pk_add_f32 v[76:77], v[76:77], v[28:29]
  v_pk_add_f32 v[78:79], v[78:79], v[30:31]
  s_waitcnt lgkmcnt(4)
  v_pk_add_f32 v[64:65], v[64:65], v[32:33]
  v_pk_add_f32 v[66:67], v[66:67], v[34:35]
  v_pk_add_f32 v[68:69], v[68:69], v[36:37]
  v_pk_add_f32 v[70:71], v[70:71], v[38:39]
  v_pk_add_f32 v[72:73], v[72:73], v[40:41]
  v_pk_add_f32 v[74:75], v[74:75], v[42:43]
  v_pk_add_f32 v[76:77], v[76:77], v[44:45]
  v_pk_add_f32 v[78:79], v[78:79], v[46:47]
  s_waitcnt lgkmcnt(0)
  v_pk_add_f32 v[64:65], v[64:65], v[48:49]
  v_pk_add_f32 v[66:67], v[66:67], v[50:51]
  v_pk_add_f32 v[68:69], v[68:69], v[52:53]
  v_pk_add_f32 v[70:71], v[70:71], v[54:55]
  v_pk_add_f32 v[72:73], v[72:73], v[56:57]
  v_pk_add_f32 v[74:75], v[74:75], v[58:59]
  v_pk_add_f32 v[76:77], v[76:77], v[60:61]
  v_pk_add_f32 v[78:79], v[78:79], v[62:63]
  s_mul_i32 s11, s13, 46080
  s_add_u32 s11, s11, 100608
  v_add_u32 v2, s11, v1
  s_mul_i32 s11, s13, 15360
  s_add_u32 s11, s11, 115968
  v_add_u32 v3, s11, v1
  v_mul_f32 v224, 0xbfb8aa3b, v64
  ds_read_b128 v[88:91], v2 offset:0
  v_mul_f32 v225, 0xbfb8aa3b, v65
  ds_read_b128 v[92:95], v3 offset:0
  v_mul_f32 v226, 0xbfb8aa3b, v66
  ds_read_b128 v[96:99], v2 offset:1024
  v_mul_f32 v227, 0xbfb8aa3b, v67
  ds_read_b128 v[100:103], v3 offset:1024
  v_mul_f32 v228, 0xbfb8aa3b, v68
  ds_read_b128 v[104:107], v2 offset:2048
  v_mul_f32 v229, 0xbfb8aa3b, v69
  ds_read_b128 v[108:111], v3 offset:2048
  v_mul_f32 v230, 0xbfb8aa3b, v70
  ds_read_b128 v[112:115], v2 offset:3072
  v_mul_f32 v231, 0xbfb8aa3b, v71
  ds_read_b128 v[116:119], v3 offset:3072
  v_exp_f32 v224, v224
  v_exp_f32 v225, v225
  v_exp_f32 v226, v226
  v_exp_f32 v227, v227
  v_exp_f32 v228, v228
  v_exp_f32 v229, v229
  v_exp_f32 v230, v230
  v_exp_f32 v231, v231
  v_add_f32 v224, 1.0, v224
  ds_read_b128 v[120:123], v2 offset:4096
  v_add_f32 v225, 1.0, v225
  ds_read_b128 v[124:127], v3 offset:4096
  v_add_f32 v226, 1.0, v226
  ds_read_b128 v[128:131], v2 offset:5120
  v_add_f32 v227, 1.0, v227
  ds_read_b128 v[132:135], v3 offset:5120
  v_add_f32 v228, 1.0, v228
  ds_read_b128 v[136:139], v2 offset:6144
  v_add_f32 v229, 1.0, v229
  ds_read_b128 v[140:143], v3 offset:6144
  v_add_f32 v230, 1.0, v230
  ds_read_b128 v[144:147], v2 offset:7168
  v_add_f32 v231, 1.0, v231
  ds_read_b128 v[148:151], v3 offset:7168
  v_rcp_f32 v224, v224
  v_rcp_f32 v225, v225
  v_rcp_f32 v226, v226
  v_rcp_f32 v227, v227
  v_rcp_f32 v228, v228
  v_rcp_f32 v229, v229
  v_rcp_f32 v230, v230
  v_rcp_f32 v231, v231
  v_mul_f32 v224, v224, v64
  v_mul_f32 v225, v225, v65
  v_mul_f32 v226, v226, v66
  v_mul_f32 v227, v227, v67
  v_mul_f32 v228, v228, v68
  v_mul_f32 v229, v229, v69
  v_mul_f32 v230, v230, v70
  v_mul_f32 v231, v231, v71
  v_mul_f32 v232, 0xbfb8aa3b, v72
  ds_read_b128 v[152:155], v2 offset:8192
  v_mul_f32 v233, 0xbfb8aa3b, v73
  ds_read_b128 v[156:159], v3 offset:8192
  v_mul_f32 v234, 0xbfb8aa3b, v74
  ds_read_b128 v[160:163], v2 offset:9216
  v_mul_f32 v235, 0xbfb8aa3b, v75
  ds_read_b128 v[164:167], v3 offset:9216
  v_mul_f32 v236, 0xbfb8aa3b, v76
  ds_read_b128 v[168:171], v2 offset:10240
  v_mul_f32 v237, 0xbfb8aa3b, v77
  ds_read_b128 v[172:175], v3 offset:10240
  v_mul_f32 v238, 0xbfb8aa3b, v78
  ds_read_b128 v[176:179], v2 offset:11264
  v_mul_f32 v239, 0xbfb8aa3b, v79
  ds_read_b128 v[180:183], v3 offset:11264
  v_exp_f32 v232, v232
  v_exp_f32 v233, v233
  v_exp_f32 v234, v234
  v_exp_f32 v235, v235
  v_exp_f32 v236, v236
  v_exp_f32 v237, v237
  v_exp_f32 v238, v238
  v_exp_f32 v239, v239
  v_add_f32 v232, 1.0, v232
  ds_read_b128 v[184:187], v2 offset:12288
  v_add_f32 v233, 1.0, v233
  ds_read_b128 v[188:191], v3 offset:12288
  v_add_f32 v234, 1.0, v234
  v_add_f32 v235, 1.0, v235
  v_add_f32 v236, 1.0, v236
  v_add_f32 v237, 1.0, v237
  v_add_f32 v238, 1.0, v238
  v_add_f32 v239, 1.0, v239
  v_rcp_f32 v232, v232
  v_rcp_f32 v233, v233
  v_rcp_f32 v234, v234
  v_rcp_f32 v235, v235
  v_rcp_f32 v236, v236
  v_rcp_f32 v237, v237
  v_rcp_f32 v238, v238
  v_rcp_f32 v239, v239
  v_mul_f32 v232, v232, v72
  v_mul_f32 v233, v233, v73
  v_mul_f32 v234, v234, v74
  v_mul_f32 v235, v235, v75
  v_mul_f32 v236, v236, v76
  v_mul_f32 v237, v237, v77
  v_mul_f32 v238, v238, v78
  v_mul_f32 v239, v239, v79
  s_waitcnt vmcnt(0)
  s_mov_b32 s13, 0xffff0000
  v_permlane32_swap_b32 v8, v10
  v_permlane32_swap_b32 v9, v11
  v_permlane32_swap_b32 v12, v14
  v_permlane32_swap_b32 v13, v15
  v_lshlrev_b32 v240, 16, v8
  v_and_b32 v241, s13, v8
  v_lshlrev_b32 v242, 16, v9
  v_and_b32 v243, s13, v9
  v_lshlrev_b32 v244, 16, v10
  v_and_b32 v245, s13, v10
  v_lshlrev_b32 v246, 16, v11
  v_and_b32 v247, s13, v11
  v_lshlrev_b32 v248, 16, v12
  v_and_b32 v249, s13, v12
  v_lshlrev_b32 v250, 16, v13
  v_and_b32 v251, s13, v13
  v_lshlrev_b32 v252, 16, v14
  v_and_b32 v253, s13, v14
  v_lshlrev_b32 v254, 16, v15
  v_and_b32 v255, s13, v15
  s_xor_b32 s11, s3, 2
  s_mul_i32 s12, s11, 12288
  s_add_u32 s12, s12, 49152
  v_add_u32 v8, s12, v1
  s_lshl_b32 s12, s3, 2
  s_add_u32 s12, s12, 100368
  v_mov_b32 v9, s12
  v_xor_b32 v10, 8, v9
  v_mov_b32 v11, 1
L_k2_apoll2:
  ds_read_b32 v5, v4 offset:8
  s_waitcnt lgkmcnt(0)
  v_readfirstlane_b32 s11, v5
  s_cmp_ge_u32 s11, 1
  s_cbranch_scc1 L_k2_ogo
  s_sleep 1
  s_branch L_k2_apoll2
L_k2_ogo:
  s_sleep 8
  buffer_load_dwordx4 v[16:19], v1, s[36:39], s24 offen offset:0 sc1
  buffer_load_dwordx4 v[20:23], v1, s[36:39], s24 offen offset:1024 sc1
  buffer_load_dwordx4 v[24:27], v1, s[36:39], s24 offen offset:2048 sc1
  buffer_load_dwordx4 v[28:31], v1, s[36:39], s24 offen offset:3072 sc1
  s_sleep 2
  buffer_load_dwordx4 v[32:35], v1, s[36:39], s25 offen offset:0 sc1
  buffer_load_dwordx4 v[36:39], v1, s[36:39], s25 offen offset:1024 sc1
  buffer_load_dwordx4 v[40:43], v1, s[36:39], s25 offen offset:2048 sc1
  buffer_load_dwordx4 v[44:47], v1, s[36:39], s25 offen offset:3072 sc1
  s_sleep 2
  buffer_load_dwordx4 v[48:51], v1, s[36:39], s26 offen offset:0 sc1
  buffer_load_dwordx4 v[52:55], v1, s[36:39], s26 offen offset:1024 sc1
  buffer_load_dwordx4 v[56:59], v1, s[36:39], s26 offen offset:2048 sc1
  buffer_load_dwordx4 v[60:63], v1, s[36:39], s26 offen offset:3072 sc1
  s_sleep 2
  buffer_load_dwordx4 v[64:67], v1, s[36:39], s27 offen offset:0 sc1
  buffer_load_dwordx4 v[68:71], v1, s[36:39], s27 offen offset:1024 sc1
  buffer_load_dwordx4 v[72:75], v1, s[36:39], s27 offen offset:2048 sc1
  buffer_load_dwordx4 v[76:79], v1, s[36:39], s27 offen offset:3072 sc1
  s_waitcnt vmcnt(12)
  v_max3_u32 v12, v16, v17, v18
  v_max3_u32 v5, v19, v20, v21
  v_max3_u32 v12, v12, v22, v23
  v_max3_u32 v5, v5, v24, v25
  v_max3_u32 v12, v12, v26, v27
  v_max3_u32 v5, v5, v28, v29
  v_max3_u32 v12, v12, v30, v31
  v_max_u32 v12, v12, v5
  v_cmp_eq_u32 vcc, -1, v12
  s_cbranch_vccnz L_k2_retry0
L_k2_ok0:
  v_mfma_f32_32x32x16_bf16 v[208:223], v[84:87], v[16:19], 0
  ds_read_b128 v[84:87], v3 offset:13312
  v_mfma_f32_32x32x16_bf16 v[192:207], v[80:83], v[16:19], 0
  ds_read_b128 v[80:83], v2 offset:13312
  v_mfma_f32_32x32x16_bf16 v[208:223], v[92:95], v[20:23], v[208:223]
  ds_read_b128 v[92:95], v3 offset:14336
  v_mfma_f32_32x32x16_bf16 v[192:207], v[88:91], v[20:23], v[192:207]
  ds_read_b128 v[88:91], v2 offset:14336
  s_waitcnt vmcnt(8)
  v_max3_u32 v12, v32, v33, v34
  v_mfma_f32_32x32x16_bf16 v[208:223], v[100:103], v[24:27], v[208:223]
  v_max3_u32 v5, v35, v36, v37
  v_max3_u32 v12, v12, v38, v39
  v_mfma_f32_32x32x16_bf16 v[192:207], v[96:99], v[24:27], v[192:207]
  v_max3_u32 v5, v5, v40, v41
  v_max3_u32 v12, v12, v42, v43
  v_mfma_f32_32x32x16_bf16 v[208:223], v[108:111], v[28:31], v[208:223]
  v_max3_u32 v5, v5, v44, v45
  v_max3_u32 v12, v12, v46, v47
  v_mfma_f32_32x32x16_bf16 v[192:207], v[104:107], v[28:31], v[192:207]
  v_max_u32 v12, v12, v5
  v_cmp_eq_u32 vcc, -1, v12
  s_cbranch_vccnz L_k2_retry1
L_k2_ok1:
  v_mfma_f32_32x32x16_bf16 v[208:223], v[116:119], v[32:35], v[208:223]
  v_mfma_f32_32x32x16_bf16 v[192:207], v[112:115], v[32:35], v[192:207]
  v_mfma_f32_32x32x16_bf16 v[208:223], v[124:127], v[36:39], v[208:223]
  v_mfma_f32_32x32x16_bf16 v[192:207], v[120:123], v[36:39], v[192:207]
  s_waitcnt vmcnt(4)
  v_max3_u32 v12, v48, v49, v50
  v_mfma_f32_32x32x16_bf16 v[208:223], v[132:135], v[40:43], v[208:223]
  v_max3_u32 v5, v51, v52, v53
  v_max3_u32 v12, v12, v54, v55
  v_mfma_f32_32x32x16_bf16 v[192:207], v[128:131], v[40:43], v[192:207]
  v_max3_u32 v5, v5, v56, v57
  v_max3_u32 v12, v12, v58, v59
  v_mfma_f32_32x32x16_bf16 v[208:223], v[140:143], v[44:47], v[208:223]
  v_max3_u32 v5, v5, v60, v61
  v_max3_u32 v12, v12, v62, v63
  v_mfma_f32_32x32x16_bf16 v[192:207], v[136:139], v[44:47], v[192:207]
  v_max_u32 v12, v12, v5
  v_cmp_eq_u32 vcc, -1, v12
  s_cbranch_vccnz L_k2_retry2
L_k2_ok2:
  v_mfma_f32_32x32x16_bf16 v[208:223], v[148:151], v[48:51], v[208:223]
  v_mfma_f32_32x32x16_bf16 v[192:207], v[144:147], v[48:51], v[192:207]
  v_mfma_f32_32x32x16_bf16 v[208:223], v[156:159], v[52:55], v[208:223]
  v_mfma_f32_32x32x16_bf16 v[192:207], v[152:155], v[52:55], v[192:207]
  s_waitcnt vmcnt(0)
  v_max3_u32 v12, v64, v65, v66
  v_mfma_f32_32x32x16_bf16 v[208:223], v[164:167], v[56:59], v[208:223]
  v_max3_u32 v5, v67, v68, v69
  v_max3_u32 v12, v12, v70, v71
  v_mfma_f32_32x32x16_bf16 v[192:207], v[160:163], v[56:59], v[192:207]
  v_max3_u32 v5, v5, v72, v73
  v_max3_u32 v12, v12, v74, v75
  v_mfma_f32_32x32x16_bf16 v[208:223], v[172:175], v[60:63], v[208:223]
  v_max3_u32 v5, v5, v76, v77
  v_max3_u32 v12, v12, v78, v79
  v_mfma_f32_32x32x16_bf16 v[192:207], v[168:171], v[60:63], v[192:207]
  v_max_u32 v12, v12, v5
  v_cmp_eq_u32 vcc, -1, v12
  s_cbranch_vccnz L_k2_retry3
L_k2_ok3:
  v_mfma_f32_32x32x16_bf16 v[208:223], v[180:183], v[64:67], v[208:223]
  v_mfma_f32_32x32x16_bf16 v[208:223], v[188:191], v[68:71], v[208:223]
  s_waitcnt lgkmcnt(3)
  v_mfma_f32_32x32x16_bf16 v[208:223], v[84:87], v[72:75], v[208:223]
  s_waitcnt lgkmcnt(1)
  v_mfma_f32_32x32x16_bf16 v[208:223], v[92:95], v[76:79], v[208:223]
  v_mfma_f32_32x32x16_bf16 v[192:207], v[176:179], v[64:67], v[192:207]
  v_mfma_f32_32x32x16_bf16 v[192:207], v[184:187], v[68:71], v[192:207]
  s_nop 9
  ds_write_b128 v6, v[208:211] offset:0
  ds_write_b128 v6, v[212:215] offset:1024
  ds_write_b128 v6, v[216:219] offset:2048
  ds_write_b128 v6, v[220:223] offset:3072
  s_waitcnt lgkmcnt(0)
  ds_write_b32 v9, v11
  s_waitcnt lgkmcnt(7)
  v_mfma_f32_32x32x16_bf16 v[192:207], v[80:83], v[72:75], v[192:207]
  s_waitcnt lgkmcnt(5)
  v_mfma_f32_32x32x16_bf16 v[192:207], v[88:91], v[76:79], v[192:207]
L_k2_poll3:
  ds_read_b32 v5, v10
  s_waitcnt lgkmcnt(0)
  v_readfirstlane_b32 s11, v5
  s_cmp_eq_u32 s11, 0
  s_cbranch_scc1 L_k2_poll3
  ds_read_b128 v[208:211], v8 offset:0
  ds_read_b128 v[212:215], v8 offset:1024
  ds_read_b128 v[216:219], v8 offset:2048
  ds_read_b128 v[220:223], v8 offset:3072
  s_waitcnt lgkmcnt(3)
  s_nop 1
  v_pk_add_f32 v[192:193], v[192:193], v[208:209]
  v_pk_add_f32 v[194:195], v[194:195], v[210:211]
  s_waitcnt lgkmcnt(2)
  v_pk_add_f32 v[196:197], v[196:197], v[212:213]
  v_pk_add_f32 v[198:199], v[198:199], v[214:215]
  v_pk_fma_f32 v[240:241], v[192:193], v[224:225], v[240:241]
  v_pk_fma_f32 v[242:243], v[194:195], v[226:227], v[242:243]
  v_pk_fma_f32 v[244:245], v[196:197], v[228:229], v[244:245]
  v_pk_fma_f32 v[246:247], v[198:199], v[230:231], v[246:247]
  v_cvt_pk_bf16_f32 v16, v240, v241
  v_cvt_pk_bf16_f32 v17, v242, v243
  v_cvt_pk_bf16_f32 v18, v244, v245
  v_cvt_pk_bf16_f32 v19, v246, v247
  s_nop 0
  v_permlane32_swap_b32 v16, v18
  v_permlane32_swap_b32 v17, v19
  buffer_store_dwordx4 v[16:19], v7, s[52:55], s56 offen offset:0
  s_waitcnt lgkmcnt(1)
  v_pk_add_f32 v[200:201], v[200:201], v[216:217]
  v_pk_add_f32 v[202:203], v[202:203], v[218:219]
  s_waitcnt lgkmcnt(0)
  v_pk_add_f32 v[204:205], v[204:205], v[220:221]
  v_pk_add_f32 v[206:207], v[206:207], v[222:223]
  v_pk_fma_f32 v[248:249], v[200:201], v[232:233], v[248:249]
  v_pk_fma_f32 v[250:251], v[202:203], v[234:235], v[250:251]
  v_pk_fma_f32 v[252:253], v[204:205], v[236:237], v[252:253]
  v_pk_fma_f32 v[254:255], v[206:207], v[238:239], v[254:255]
  v_cvt_pk_bf16_f32 v20, v248, v249
  v_cvt_pk_bf16_f32 v21, v250, v251
  v_cvt_pk_bf16_f32 v22, v252, v253
  v_cvt_pk_bf16_f32 v23, v254, v255
  s_nop 0
  v_permlane32_swap_b32 v20, v22
  v_permlane32_swap_b32 v21, v23
  buffer_store_dwordx4 v[20:23], v7, s[52:55], s56 offen offset:32
L_k2_exit:
  s_endpgm
L_k2_retry0:
  s_add_u32 s57, s57, 1
  s_cmp_ge_u32 s57, 20000
  s_cbranch_scc1 L_k2_ok0
  s_sleep 4
  buffer_load_dwordx4 v[16:19], v1, s[36:39], s24 offen offset:0 sc1
  buffer_load_dwordx4 v[20:23], v1, s[36:39], s24 offen offset:1024 sc1
  buffer_load_dwordx4 v[24:27], v1, s[36:39], s24 offen offset:2048 sc1
  buffer_load_dwordx4 v[28:31], v1, s[36:39], s24 offen offset:3072 sc1
  buffer_load_dwordx4 v[32:35], v1, s[36:39], s25 offen offset:0 sc1
  buffer_load_dwordx4 v[36:39], v1, s[36:39], s25 offen offset:1024 sc1
  buffer_load_dwordx4 v[40:43], v1, s[36:39], s25 offen offset:2048 sc1
  buffer_load_dwordx4 v[44:47], v1, s[36:39], s25 offen offset:3072 sc1
  buffer_load_dwordx4 v[48:51], v1, s[36:39], s26 offen offset:0 sc1
  buffer_load_dwordx4 v[52:55], v1, s[36:39], s26 offen offset:1024 sc1
  buffer_load_dwordx4 v[56:59], v1, s[36:39], s26 offen offset:2048 sc1
  buffer_load_dwordx4 v[60:63], v1, s[36:39], s26 offen offset:3072 sc1
  buffer_load_dwordx4 v[64:67], v1, s[36:39], s27 offen offset:0 sc1
  buffer_load_dwordx4 v[68:71], v1, s[36:39], s27 offen offset:1024 sc1
  buffer_load_dwordx4 v[72:75], v1, s[36:39], s27 offen offset:2048 sc1
  buffer_load_dwordx4 v[76:79], v1, s[36:39], s27 offen offset:3072 sc1
L_k2_rc0:
  s_waitcnt vmcnt(12)
  v_max3_u32 v12, v16, v17, v18
  v_max3_u32 v5, v19, v20, v21
  v_max3_u32 v12, v12, v22, v23
  v_max3_u32 v5, v5, v24, v25
  v_max3_u32 v12, v12, v26, v27
  v_max3_u32 v5, v5, v28, v29
  v_max3_u32 v12, v12, v30, v31
  v_max_u32 v12, v12, v5
  v_cmp_eq_u32 vcc, -1, v12
  s_cbranch_vccnz L_k2_retry0
  s_branch L_k2_ok0
L_k2_retry1:
  s_add_u32 s57, s57, 1
  s_cmp_ge_u32 s57, 20000
  s_cbranch_scc1 L_k2_ok1
  s_sleep 4
  buffer_load_dwordx4 v[32:35], v1, s[36:39], s25 offen offset:0 sc1
  buffer_load_dwordx4 v[36:39], v1, s[36:39], s25 offen offset:1024 sc1
  buffer_load_dwordx4 v[40:43], v1, s[36:39], s25 offen offset:2048 sc1
  buffer_load_dwordx4 v[44:47], v1, s[36:39], s25 offen offset:3072 sc1
  buffer_load_dwordx4 v[48:51], v1, s[36:39], s26 offen offset:0 sc1
  buffer_load_dwordx4 v[52:55], v1, s[36:39], s26 offen offset:1024 sc1
  buffer_load_dwordx4 v[56:59], v1, s[36:39], s26 offen offset:2048 sc1
  buffer_load_dwordx4 v[60:63], v1, s[36:39], s26 offen offset:3072 sc1
  buffer_load_dwordx4 v[64:67], v1, s[36:39], s27 offen offset:0 sc1
  buffer_load_dwordx4 v[68:71], v1, s[36:39], s27 offen offset:1024 sc1
  buffer_load_dwordx4 v[72:75], v1, s[36:39], s27 offen offset:2048 sc1
  buffer_load_dwordx4 v[76:79], v1, s[36:39], s27 offen offset:3072 sc1
L_k2_rc1:
  s_waitcnt vmcnt(8)
  v_max3_u32 v12, v32, v33, v34
  v_max3_u32 v5, v35, v36, v37
  v_max3_u32 v12, v12, v38, v39
  v_max3_u32 v5, v5, v40, v41
  v_max3_u32 v12, v12, v42, v43
  v_max3_u32 v5, v5, v44, v45
  v_max3_u32 v12, v12, v46, v47
  v_max_u32 v12, v12, v5
  v_cmp_eq_u32 vcc, -1, v12
  s_cbranch_vccnz L_k2_retry1
  s_branch L_k2_ok1
L_k2_retry2:
  s_add_u32 s57, s57, 1
  s_cmp_ge_u32 s57, 20000
  s_cbranch_scc1 L_k2_ok2
  s_sleep 4
  buffer_load_dwordx4 v[48:51], v1, s[36:39], s26 offen offset:0 sc1
  buffer_load_dwordx4 v[52:55], v1, s[36:39], s26 offen offset:1024 sc1
  buffer_load_dwordx4 v[56:59], v1, s[36:39], s26 offen offset:2048 sc1
  buffer_load_dwordx4 v[60:63], v1, s[36:39], s26 offen offset:3072 sc1
  buffer_load_dwordx4 v[64:67], v1, s[36:39], s27 offen offset:0 sc1
  buffer_load_dwordx4 v[68:71], v1, s[36:39], s27 offen offset:1024 sc1
  buffer_load_dwordx4 v[72:75], v1, s[36:39], s27 offen offset:2048 sc1
  buffer_load_dwordx4 v[76:79], v1, s[36:39], s27 offen offset:3072 sc1
L_k2_rc2:
  s_waitcnt vmcnt(4)
  v_max3_u32 v12, v48, v49, v50
  v_max3_u32 v5, v51, v52, v53
  v_max3_u32 v12, v12, v54, v55
  v_max3_u32 v5, v5, v56, v57
  v_max3_u32 v12, v12, v58, v59
  v_max3_u32 v5, v5, v60, v61
  v_max3_u32 v12, v12, v62, v63
  v_max_u32 v12, v12, v5
  v_cmp_eq_u32 vcc, -1, v12
  s_cbranch_vccnz L_k2_retry2
  s_branch L_k2_ok2
L_k2_retry3:
  s_add_u32 s57, s57, 1
  s_cmp_ge_u32 s57, 20000
  s_cbranch_scc1 L_k2_ok3
  s_sleep 4
  buffer_load_dwordx4 v[64:67], v1, s[36:39], s27 offen offset:0 sc1
  buffer_load_dwordx4 v[68:71], v1, s[36:39], s27 offen offset:1024 sc1
  buffer_load_dwordx4 v[72:75], v1, s[36:39], s27 offen offset:2048 sc1
  buffer_load_dwordx4 v[76:79], v1, s[36:39], s27 offen offset:3072 sc1
L_k2_rc3:
  s_waitcnt vmcnt(0)
  v_max3_u32 v12, v64, v65, v66
  v_max3_u32 v5, v67, v68, v69
  v_max3_u32 v12, v12, v70, v71
  v_max3_u32 v5, v5, v72, v73
  v_max3_u32 v12, v12, v74, v75
  v_max3_u32 v5, v5, v76, v77
  v_max3_u32 v12, v12, v78, v79
  v_max_u32 v12, v12, v5
  v_cmp_eq_u32 vcc, -1, v12
  s_cbranch_vccnz L_k2_retry3
  s_branch L_k2_ok3

L_text_end:
.section .rodata,"a"
.p2align 6
.amdhsa_kernel proj_kernel
  .amdhsa_next_free_vgpr 256
  .amdhsa_next_free_sgpr 102
  .amdhsa_accum_offset 256
  .amdhsa_group_segment_fixed_size 0
  .amdhsa_kernarg_size 80
  .amdhsa_user_sgpr_count 2
  .amdhsa_user_sgpr_kernarg_segment_ptr 1
  .amdhsa_system_sgpr_workgroup_id_x 1
.end_amdhsa_kernel
.p2align 6
.amdhsa_kernel attn_kernel
  .amdhsa_next_free_vgpr 256
  .amdhsa_next_free_sgpr 102
  .amdhsa_accum_offset 256
  .amdhsa_group_segment_fixed_size 0
  .amdhsa_kernarg_size 80
  .amdhsa_user_sgpr_count 2
  .amdhsa_user_sgpr_kernarg_segment_ptr 1
  .amdhsa_system_sgpr_workgroup_id_x 1
  .amdhsa_system_sgpr_workgroup_id_y 1
.end_amdhsa_kernel
```
